```python
import torch

def _softmax(x, axis=-1):
    return torch.softmax(x, dim=axis)
def _gelu(x):
    return torch.nn.functional.gelu(x, approximate="tanh")
def _silu(x):
    return torch.nn.functional.silu(x)
def _sigmoid(x):
    return torch.sigmoid(x)
def _layernorm(x, axis=-1, eps=1e-5):
    m = x.mean(dim=axis, keepdim=True)
    v = x.var(dim=axis, keepdim=True, unbiased=False)
    return (x - m) / torch.sqrt(v + eps)
def _scatter_add(tgt, idx, src, axis=0):
    return tgt.clone().index_add_(axis, idx, src)
def _segment_sum(src, seg, n):
    out = torch.zeros((n,) + src.shape[1:], dtype=src.dtype)
    return out.index_add_(0, seg, src)
def _pad(x, pw):
    flat = tuple(v for pair in reversed(pw) for v in pair)
    return torch.nn.functional.pad(x, flat)

kernel_name = 'concat_heads__gqa_block_cached__gqa_block_cached__near_ridge'

def setup_inputs():

    _w = (lambda a: (lambda t: t.to(torch.bfloat16) if t.is_floating_point() else t)(torch.as_tensor(a)))
    def _A_setup():
        B, Sq, D = 8, 208, 640
        Hq, Hkv, Sk, Dh = 32, 32, 1024, 128
        assert Hq % Hkv == 0, (Hq, Hkv)
        return {
            "x": _w((lambda *s: torch.randn(*s, dtype=torch.bfloat16) * 0.8)(B, Sq, D)),
            "k_cache": _w((lambda *s: torch.randn(*s, dtype=torch.bfloat16) * 0.8)(B, Hkv, Sk, Dh)),
            "v_cache": _w((lambda *s: torch.randn(*s, dtype=torch.bfloat16) * 0.05)(B, Hkv, Sk, Dh)),
            "wq": _w((lambda *s: torch.randn(*s, dtype=torch.bfloat16) * 0.8)(D, Hq * Dh) * (D ** -0.5)),
            "wo": _w((lambda *s: torch.randn(*s, dtype=torch.bfloat16) * 0.05)(Hq * Dh, D) * ((Hq * Dh) ** -0.5)),
        }
    _A_in = _A_setup()

    def _B_setup():
        B, Sq, D = 8, 208, 640
        Hq, Hkv, Sk, Dh = 32, 32, 1024, 128
        assert Hq % Hkv == 0, (Hq, Hkv)
        return {
            "x": _w((lambda *s: torch.randn(*s, dtype=torch.bfloat16) * 0.8)(B, Sq, D)),
            "k_cache": _w((lambda *s: torch.randn(*s, dtype=torch.bfloat16) * 0.8)(B, Hkv, Sk, Dh)),
            "v_cache": _w((lambda *s: torch.randn(*s, dtype=torch.bfloat16) * 0.05)(B, Hkv, Sk, Dh)),
            "wq": _w((lambda *s: torch.randn(*s, dtype=torch.bfloat16) * 0.8)(D, Hq * Dh) * (D ** -0.5)),
            "wo": _w((lambda *s: torch.randn(*s, dtype=torch.bfloat16) * 0.05)(Hq * Dh, D) * ((Hq * Dh) ** -0.5)),
        }
    _B_in = _B_setup()

    return {
        "A_x": _A_in["x"],
        "A_k_cache": _A_in["k_cache"],
        "A_v_cache": _A_in["v_cache"],
        "A_wq": _A_in["wq"],
        "A_wo": _A_in["wo"],
        "B_x": _B_in["x"],
        "B_k_cache": _B_in["k_cache"],
        "B_v_cache": _B_in["v_cache"],
        "B_wq": _B_in["wq"],
        "B_wo": _B_in["wo"],
    }

def reference(A_x, A_k_cache, A_v_cache, A_wq, A_wo, B_x, B_k_cache, B_v_cache, B_wq, B_wo):
    def _A_ref(x, k_cache, v_cache, wq, wo):
        B, Sq, D = x.shape
        Hq, Dh = 32, 128
        Hkv = k_cache.shape[1]
        rep = Hq // Hkv
        q = (lambda x, *d: x.permute(*d))((x @ wq).reshape(B, Sq, Hq, Dh), 0, 2, 1, 3)
        k = (lambda x, n, axis: torch.repeat_interleave(x, n, dim=axis))(k_cache, rep, axis=1)
        v = (lambda x, n, axis: torch.repeat_interleave(x, n, dim=axis))(v_cache, rep, axis=1)
        scores = torch.einsum("bhqd,bhkd->bhqk", q, k) * (Dh ** -0.5)
        p = _softmax(scores, axis=-1)
        o = torch.einsum("bhqk,bhkd->bhqd", p, v)
        return (lambda x, *d: x.permute(*d))(o, 0, 2, 1, 3).reshape(B, Sq, Hq * Dh) @ wo

    def _B_ref(x, k_cache, v_cache, wq, wo):
        B, Sq, D = x.shape
        Hq, Dh = 32, 128
        Hkv = k_cache.shape[1]
        rep = Hq // Hkv
        q = (lambda x, *d: x.permute(*d))((x @ wq).reshape(B, Sq, Hq, Dh), 0, 2, 1, 3)
        k = (lambda x, n, axis: torch.repeat_interleave(x, n, dim=axis))(k_cache, rep, axis=1)
        v = (lambda x, n, axis: torch.repeat_interleave(x, n, dim=axis))(v_cache, rep, axis=1)
        scores = torch.einsum("bhqd,bhkd->bhqk", q, k) * (Dh ** -0.5)
        p = _softmax(scores, axis=-1)
        o = torch.einsum("bhqk,bhkd->bhqd", p, v)
        return (lambda x, *d: x.permute(*d))(o, 0, 2, 1, 3).reshape(B, Sq, Hq * Dh) @ wo

    a = _A_ref(A_x, A_k_cache, A_v_cache, A_wq, A_wo)
    b = _B_ref(B_x, B_k_cache, B_v_cache, B_wq, B_wo)
    return torch.concatenate([a, b], axis=-1)
```

```asm
; @launch kernel=attn_kernel grid=(512,1,1) block=(256,1,1) lds=81920
; @launch kernel=oproj_kernel grid=(256,1,1) block=(512,1,1) lds=163840
.amdgcn_target "amdgcn-amd-amdhsa--gfx950"
.text
.globl attn_kernel
.p2align 8
.type attn_kernel,@function
attn_kernel:
    s_cmp_ge_u32 s2, 512
    s_cbranch_scc1 L_k1_end
    s_load_dwordx16 s[64:79], s[0:1], 0
    s_load_dwordx4 s[80:83], s[0:1], 64
    s_load_dwordx2 s[84:85], s[0:1], 96
    s_and_b32 s3, s2, 7
    s_lshr_b32 s4, s2, 3
    s_lshr_b32 s5, s3, 2
    s_and_b32 s6, s4, 7
    s_and_b32 s7, s3, 3
    s_lshl_b32 s7, s7, 3
    s_lshr_b32 s4, s4, 3
    s_add_u32 s57, s7, s4
    v_lshrrev_b32 v1, 6, v0
    v_and_b32 v0, 63, v0
    v_readfirstlane_b32 s28, v1
    s_waitcnt lgkmcnt(0)
    s_cmp_eq_u32 s5, 0
    s_cselect_b64 s[86:87], s[64:65], s[74:75]
    s_cselect_b64 s[88:89], s[66:67], s[76:77]
    s_cselect_b64 s[90:91], s[68:69], s[78:79]
    s_cselect_b64 s[92:93], s[70:71], s[80:81]
    s_mul_i32 s3, s6, 266240
    s_add_u32 s86, s86, s3
    s_addc_u32 s87, s87, 0
    s_mov_b32 s8, s86
    s_and_b32 s9, s87, 0xffff
    s_mov_b32 s10, 266240
    s_mov_b32 s11, 0x20000
    s_lshl_b32 s3, s57, 8
    s_add_u32 s92, s92, s3
    s_addc_u32 s93, s93, 0
    s_sub_u32 s4, 5242880, s3
    s_mov_b32 s12, s92
    s_and_b32 s13, s93, 0xffff
    s_mov_b32 s14, s4
    s_mov_b32 s15, 0x20000
    s_lshl_b32 s3, s2, 2
    s_add_u32 s3, s3, s28
    s_lshr_b32 s4, s3, 10
    s_cmp_eq_u32 s4, 0
    s_cselect_b64 s[64:65], s[72:73], s[82:83]
    s_and_b32 s66, s3, 7
    s_bfe_u32 s67, s3, 0x70003
    s_lshl_b32 s4, s4, 3
    s_add_u32 s4, s4, s66
    s_lshl_b32 s4, s4, 7
    s_add_u32 s4, s4, s67
    s_mul_i32 s4, s4, 5120
    s_add_u32 s4, s4, 62914560
    s_add_u32 s68, s84, s4
    s_addc_u32 s69, s85, 0
    s_mul_i32 s66, s66, 160
    s_mul_i32 s67, s67, 40960
    s_add_u32 s67, s67, s66
    s_lshl_b32 s3, s6, 5
    s_add_u32 s3, s3, s57
    s_lshl_b32 s3, s3, 18
    s_add_u32 s88, s88, s3
    s_addc_u32 s89, s89, 0
    s_add_u32 s90, s90, s3
    s_addc_u32 s91, s91, 0
    s_mov_b32 s16, s88
    s_and_b32 s17, s89, 0xffff
    s_mov_b32 s18, 262144
    s_mov_b32 s19, 0x20000
    s_mov_b32 s20, s90
    s_and_b32 s21, s91, 0xffff
    s_mov_b32 s22, 262144
    s_mov_b32 s23, 0x20000
    s_lshl_b32 s3, s5, 3
    s_add_u32 s3, s3, s6
    s_mul_i32 s3, s3, 1703936
    s_add_u32 s84, s84, s3
    s_addc_u32 s85, s85, 0
    s_mov_b32 s24, s84
    s_and_b32 s25, s85, 0xffff
    s_mov_b32 s26, 1703936
    s_mov_b32 s27, 0x20000
    s_and_b32 s29, s28, 1
    s_lshr_b32 s30, s28, 1
    s_mul_i32 s31, s28, 2080
    s_mul_i32 s32, s28, 2112
    s_mul_i32 s33, s28, 61440
    s_add_u32 s34, s33, 20480
    s_add_u32 s35, s33, 40960
    s_mov_b32 s36, 245760
    s_mov_b32 s56, 0
    v_lshrrev_b32 v1, 4, v0
    v_bfe_u32 v2, v0, 2, 2
    v_and_b32 v3, 3, v0
    v_and_b32 v4, 15, v0
    v_lshlrev_b32 v76, 8, v2
    v_lshl_add_u32 v76, v1, 6, v76
    v_lshl_add_u32 v76, v3, 4, v76
    s_lshl_b32 s3, s28, 11
    v_add_u32 v76, s3, v76
    s_mul_i32 s33, s28, 61440
    s_mul_i32 s34, s28, 6528
    v_xor_b32 v12, v3, v1
    v_and_b32 v13, 4, v0
    v_or_b32 v12, v12, v13
    v_lshrrev_b32 v6, 3, v0
    v_mul_u32_u24 v6, 1280, v6
    v_lshl_add_u32 v6, v12, 4, v6
    v_lshlrev_b32 v5, 13, v2
    v_lshl_add_u32 v5, v1, 6, v5
    v_lshl_add_u32 v5, v3, 4, v5
    s_lshl_b32 s3, s28, 16
    v_add_u32 v5, s3, v5
    s_cmp_lg_u32 s28, 3
    s_cbranch_scc1 L_x12_0
    s_mov_b32 s54, 245760
    s_mov_b32 m0, 67712
    s_nop 0
    buffer_load_dwordx4 v6, s[8:11], s54 offen lds
    s_mov_b32 s54, 256000
    s_mov_b32 m0, 68800
    s_nop 0
    buffer_load_dwordx4 v6, s[8:11], s54 offen lds
L_x12_0:
    s_add_u32 s54, s33, 0
    s_add_u32 m0, s34, 0
    s_nop 0
    buffer_load_dwordx4 v6, s[8:11], s54 offen lds
    s_add_u32 s54, s33, 10240
    s_add_u32 m0, s34, 1088
    s_nop 0
    buffer_load_dwordx4 v6, s[8:11], s54 offen lds
    s_add_u32 s54, s33, 20480
    s_add_u32 m0, s34, 2176
    s_nop 0
    buffer_load_dwordx4 v6, s[8:11], s54 offen lds
    s_add_u32 s54, s33, 30720
    s_add_u32 m0, s34, 3264
    s_nop 0
    buffer_load_dwordx4 v6, s[8:11], s54 offen lds
    s_add_u32 s54, s33, 40960
    s_add_u32 m0, s34, 4352
    s_nop 0
    buffer_load_dwordx4 v6, s[8:11], s54 offen lds
    s_add_u32 s54, s33, 51200
    s_add_u32 m0, s34, 5440
    s_nop 0
    buffer_load_dwordx4 v6, s[8:11], s54 offen lds
    s_mov_b32 s55, 0
    s_add_u32 m0, s31, 26112
    s_nop 0
    buffer_load_dwordx4 v5, s[12:15], s55 offen lds
    s_mov_b32 s55, 32768
    s_add_u32 m0, s31, 27152
    s_nop 0
    buffer_load_dwordx4 v5, s[12:15], s55 offen lds
    s_mov_b32 s55, 262144
    s_add_u32 m0, s31, 34432
    s_nop 0
    buffer_load_dwordx4 v5, s[12:15], s55 offen lds
    s_mov_b32 s55, 294912
    s_add_u32 m0, s31, 35472
    s_nop 0
    buffer_load_dwordx4 v5, s[12:15], s55 offen lds
    s_mov_b32 s55, 524288
    s_add_u32 m0, s31, 42752
    s_nop 0
    buffer_load_dwordx4 v5, s[12:15], s55 offen lds
    s_mov_b32 s55, 557056
    s_add_u32 m0, s31, 43792
    s_nop 0
    buffer_load_dwordx4 v5, s[12:15], s55 offen lds
    s_mov_b32 s55, 786432
    s_add_u32 m0, s31, 51072
    s_nop 0
    buffer_load_dwordx4 v5, s[12:15], s55 offen lds
    s_mov_b32 s55, 819200
    s_add_u32 m0, s31, 52112
    s_nop 0
    buffer_load_dwordx4 v5, s[12:15], s55 offen lds
    v_mul_u32_u24 v7, 2080, v1
    v_lshl_add_u32 v7, v2, 6, v7
    v_lshl_add_u32 v7, v3, 3, v7
    v_lshrrev_b32 v12, 3, v4
    v_mul_u32_u24 v11, 1088, v12
    v_and_b32 v12, 7, v4
    v_lshl_add_u32 v11, v12, 7, v11
    v_bfe_u32 v12, v4, 1, 2
    v_xor_b32 v12, v12, v1
    v_lshl_add_u32 v11, v12, 4, v11
    v_add_u32 v10, s34, v11
    v_add_u32 v11, 67712, v11
    v_lshlrev_b32 v15, 4, v0
    v_mul_u32_u24 v72, 1056, v2
    v_lshl_add_u32 v72, v3, 6, v72
    v_lshl_add_u32 v72, v1, 4, v72
    v_mul_u32_u24 v74, 1056, v1
    v_lshl_add_u32 v74, v2, 6, v74
    v_lshl_add_u32 v74, v3, 3, v74
    s_mul_i32 s3, s29, 4224
    s_sub_u32 s4, 4224, s3
    v_add_u32 v73, s4, v72
    v_add_u32 v72, s3, v72
    v_add_u32 v75, s4, v74
    v_add_u32 v74, s3, v74
    s_mov_b32 s52, 0
    s_mov_b32 s53, 0
    v_add_u32 v77, 76032, v15
    v_mov_b32 v13, 80128
    v_mov_b32 v12, 0
    ds_write_b32 v13, v12 offset:0
    s_lshl_b32 s35, s28, 8
    s_waitcnt vmcnt(6)
    s_waitcnt lgkmcnt(0)
    s_barrier
    ds_read_b128 a[104:107], v10 offset:0
    ds_read_b128 a[108:111], v10 offset:64
    ds_read_b128 a[112:115], v10 offset:2176
    ds_read_b128 a[116:119], v10 offset:2240
    ds_read_b128 a[120:123], v10 offset:4352
    ds_read_b128 a[124:127], v10 offset:4416
    s_waitcnt vmcnt(4)
    s_barrier
    ds_read_b128 a[128:131], v11 offset:0
    ds_read_b128 a[132:135], v11 offset:64
    s_waitcnt lgkmcnt(2)
    v_add_u32 v8, 26112, v7
    v_add_u32 v9, s35, v8
    ds_read_b64_tr_b16 v[16:17], v8 offset:0
    ds_read_b64_tr_b16 v[18:19], v8 offset:1040
    ds_read_b64_tr_b16 v[20:21], v8 offset:32
    ds_read_b64_tr_b16 v[22:23], v8 offset:1072
    ds_read_b64_tr_b16 v[24:25], v8 offset:256
    ds_read_b64_tr_b16 v[26:27], v8 offset:1296
    ds_read_b64_tr_b16 v[28:29], v8 offset:288
    ds_read_b64_tr_b16 v[30:31], v8 offset:1328
    ds_read_b64_tr_b16 v[32:33], v8 offset:512
    ds_read_b64_tr_b16 v[34:35], v8 offset:1552
    s_waitcnt lgkmcnt(8)
    v_mfma_f32_16x16x32_bf16 a[0:3], v[16:19], a[104:107], 0
    v_mfma_f32_16x16x32_bf16 a[32:35], v[16:19], a[112:115], 0
    v_mfma_f32_16x16x32_bf16 a[64:67], v[16:19], a[120:123], 0
    s_cmp_lg_u32 s28, 3
    s_cbranch_scc1 L_x12_1
    s_mov_b32 s54, 245888
    s_mov_b32 m0, 69888
    s_nop 0
    buffer_load_dwordx4 v6, s[8:11], s54 offen lds
    s_mov_b32 s54, 256128
    s_mov_b32 m0, 70976
    s_nop 0
    buffer_load_dwordx4 v6, s[8:11], s54 offen lds
L_x12_1:
    ds_read_b64_tr_b16 v[36:37], v8 offset:544
    ds_read_b64_tr_b16 v[38:39], v8 offset:1584
    s_waitcnt lgkmcnt(8)
    v_mfma_f32_16x16x32_bf16 a[4:7], v[20:23], a[104:107], 0
    v_mfma_f32_16x16x32_bf16 a[36:39], v[20:23], a[112:115], 0
    v_mfma_f32_16x16x32_bf16 a[68:71], v[20:23], a[120:123], 0
    s_add_u32 s54, s33, 128
    s_add_u32 m0, s34, 0
    s_nop 0
    buffer_load_dwordx4 v6, s[8:11], s54 offen lds
    ds_read_b64_tr_b16 v[40:41], v8 offset:768
    ds_read_b64_tr_b16 v[42:43], v8 offset:1808
    s_waitcnt lgkmcnt(8)
    v_mfma_f32_16x16x32_bf16 a[8:11], v[24:27], a[104:107], 0
    v_mfma_f32_16x16x32_bf16 a[40:43], v[24:27], a[112:115], 0
    v_mfma_f32_16x16x32_bf16 a[72:75], v[24:27], a[120:123], 0
    s_add_u32 s54, s33, 10368
    s_add_u32 m0, s34, 1088
    s_nop 0
    buffer_load_dwordx4 v6, s[8:11], s54 offen lds
    ds_read_b64_tr_b16 v[44:45], v8 offset:800
    ds_read_b64_tr_b16 v[46:47], v8 offset:1840
    s_waitcnt lgkmcnt(8)
    v_mfma_f32_16x16x32_bf16 a[12:15], v[28:31], a[104:107], 0
    v_mfma_f32_16x16x32_bf16 a[44:47], v[28:31], a[112:115], 0
    v_mfma_f32_16x16x32_bf16 a[76:79], v[28:31], a[120:123], 0
    s_add_u32 s54, s33, 20608
    s_add_u32 m0, s34, 2176
    s_nop 0
    buffer_load_dwordx4 v6, s[8:11], s54 offen lds
    ds_read_b64_tr_b16 v[16:17], v9 offset:0
    ds_read_b64_tr_b16 v[18:19], v9 offset:1040
    s_waitcnt lgkmcnt(8)
    v_mfma_f32_16x16x32_bf16 a[16:19], v[32:35], a[104:107], 0
    v_mfma_f32_16x16x32_bf16 a[48:51], v[32:35], a[112:115], 0
    v_mfma_f32_16x16x32_bf16 a[80:83], v[32:35], a[120:123], 0
    s_add_u32 s54, s33, 30848
    s_add_u32 m0, s34, 3264
    s_nop 0
    buffer_load_dwordx4 v6, s[8:11], s54 offen lds
    ds_read_b64_tr_b16 v[20:21], v9 offset:32
    ds_read_b64_tr_b16 v[22:23], v9 offset:1072
    s_waitcnt lgkmcnt(8)
    v_mfma_f32_16x16x32_bf16 a[20:23], v[36:39], a[104:107], 0
    v_mfma_f32_16x16x32_bf16 a[52:55], v[36:39], a[112:115], 0
    v_mfma_f32_16x16x32_bf16 a[84:87], v[36:39], a[120:123], 0
    s_add_u32 s54, s33, 41088
    s_add_u32 m0, s34, 4352
    s_nop 0
    buffer_load_dwordx4 v6, s[8:11], s54 offen lds
    v_add_u32 v8, 34432, v7
    v_add_u32 v9, s35, v8
    ds_read_b64_tr_b16 v[24:25], v8 offset:0
    ds_read_b64_tr_b16 v[26:27], v8 offset:1040
    s_waitcnt lgkmcnt(8)
    v_mfma_f32_16x16x32_bf16 a[24:27], v[40:43], a[104:107], 0
    v_mfma_f32_16x16x32_bf16 a[56:59], v[40:43], a[112:115], 0
    v_mfma_f32_16x16x32_bf16 a[88:91], v[40:43], a[120:123], 0
    s_add_u32 s54, s33, 51328
    s_add_u32 m0, s34, 5440
    s_nop 0
    buffer_load_dwordx4 v6, s[8:11], s54 offen lds
    ds_read_b64_tr_b16 v[28:29], v8 offset:32
    ds_read_b64_tr_b16 v[30:31], v8 offset:1072
    s_waitcnt lgkmcnt(8)
    v_mfma_f32_16x16x32_bf16 a[28:31], v[44:47], a[104:107], 0
    v_mfma_f32_16x16x32_bf16 a[60:63], v[44:47], a[112:115], 0
    v_mfma_f32_16x16x32_bf16 a[92:95], v[44:47], a[120:123], 0
    s_mov_b32 s55, 1048576
    s_add_u32 m0, s31, 59392
    s_nop 0
    buffer_load_dwordx4 v5, s[12:15], s55 offen lds
    ds_read_b64_tr_b16 v[32:33], v8 offset:256
    ds_read_b64_tr_b16 v[34:35], v8 offset:1296
    s_waitcnt lgkmcnt(8)
    v_mfma_f32_16x16x32_bf16 a[96:99], v[16:19], a[128:131], 0
    s_mov_b32 s55, 1081344
    s_add_u32 m0, s31, 60432
    s_nop 0
    buffer_load_dwordx4 v5, s[12:15], s55 offen lds
    ds_read_b64_tr_b16 v[36:37], v8 offset:288
    ds_read_b64_tr_b16 v[38:39], v8 offset:1328
    s_waitcnt lgkmcnt(8)
    v_mfma_f32_16x16x32_bf16 a[100:103], v[20:23], a[128:131], 0
    s_waitcnt vmcnt(10)
    s_barrier
    ds_read_b64_tr_b16 v[40:41], v8 offset:512
    ds_read_b64_tr_b16 v[42:43], v8 offset:1552
    s_waitcnt lgkmcnt(8)
    v_mfma_f32_16x16x32_bf16 a[0:3], v[24:27], a[108:111], a[0:3]
    v_mfma_f32_16x16x32_bf16 a[32:35], v[24:27], a[116:119], a[32:35]
    v_mfma_f32_16x16x32_bf16 a[64:67], v[24:27], a[124:127], a[64:67]
    s_mov_b32 s55, 1310720
    s_add_u32 m0, s31, 26112
    s_nop 0
    buffer_load_dwordx4 v5, s[12:15], s55 offen lds
    ds_read_b64_tr_b16 v[44:45], v8 offset:544
    ds_read_b64_tr_b16 v[46:47], v8 offset:1584
    s_waitcnt lgkmcnt(8)
    v_mfma_f32_16x16x32_bf16 a[4:7], v[28:31], a[108:111], a[4:7]
    v_mfma_f32_16x16x32_bf16 a[36:39], v[28:31], a[116:119], a[36:39]
    v_mfma_f32_16x16x32_bf16 a[68:71], v[28:31], a[124:127], a[68:71]
    s_mov_b32 s55, 1343488
    s_add_u32 m0, s31, 27152
    s_nop 0
    buffer_load_dwordx4 v5, s[12:15], s55 offen lds
    ds_read_b64_tr_b16 v[16:17], v8 offset:768
    ds_read_b64_tr_b16 v[18:19], v8 offset:1808
    s_waitcnt lgkmcnt(8)
    v_mfma_f32_16x16x32_bf16 a[8:11], v[32:35], a[108:111], a[8:11]
    v_mfma_f32_16x16x32_bf16 a[40:43], v[32:35], a[116:119], a[40:43]
    v_mfma_f32_16x16x32_bf16 a[72:75], v[32:35], a[124:127], a[72:75]
    ds_read_b64_tr_b16 v[20:21], v8 offset:800
    ds_read_b64_tr_b16 v[22:23], v8 offset:1840
    s_waitcnt lgkmcnt(8)
    v_mfma_f32_16x16x32_bf16 a[12:15], v[36:39], a[108:111], a[12:15]
    v_mfma_f32_16x16x32_bf16 a[44:47], v[36:39], a[116:119], a[44:47]
    v_mfma_f32_16x16x32_bf16 a[76:79], v[36:39], a[124:127], a[76:79]
    ds_read_b64_tr_b16 v[24:25], v9 offset:0
    ds_read_b64_tr_b16 v[26:27], v9 offset:1040
    s_waitcnt lgkmcnt(8)
    v_mfma_f32_16x16x32_bf16 a[16:19], v[40:43], a[108:111], a[16:19]
    v_mfma_f32_16x16x32_bf16 a[48:51], v[40:43], a[116:119], a[48:51]
    v_mfma_f32_16x16x32_bf16 a[80:83], v[40:43], a[124:127], a[80:83]
    ds_read_b64_tr_b16 v[28:29], v9 offset:32
    ds_read_b64_tr_b16 v[30:31], v9 offset:1072
    s_waitcnt lgkmcnt(8)
    v_mfma_f32_16x16x32_bf16 a[20:23], v[44:47], a[108:111], a[20:23]
    v_mfma_f32_16x16x32_bf16 a[52:55], v[44:47], a[116:119], a[52:55]
    v_mfma_f32_16x16x32_bf16 a[84:87], v[44:47], a[124:127], a[84:87]
    v_add_u32 v8, 42752, v7
    v_add_u32 v9, s35, v8
    ds_read_b64_tr_b16 v[32:33], v8 offset:0
    ds_read_b64_tr_b16 v[34:35], v8 offset:1040
    s_waitcnt lgkmcnt(8)
    v_mfma_f32_16x16x32_bf16 a[24:27], v[16:19], a[108:111], a[24:27]
    v_mfma_f32_16x16x32_bf16 a[56:59], v[16:19], a[116:119], a[56:59]
    v_mfma_f32_16x16x32_bf16 a[88:91], v[16:19], a[124:127], a[88:91]
    ds_read_b64_tr_b16 v[36:37], v8 offset:32
    ds_read_b64_tr_b16 v[38:39], v8 offset:1072
    s_waitcnt vmcnt(4)
    ds_read_b128 a[136:139], v10 offset:0
    ds_read_b128 a[140:143], v10 offset:64
    ds_read_b128 a[144:147], v10 offset:2176
    ds_read_b128 a[148:151], v10 offset:2240
    ds_read_b128 a[152:155], v10 offset:4352
    ds_read_b128 a[156:159], v10 offset:4416
    s_waitcnt lgkmcnt(14)
    v_mfma_f32_16x16x32_bf16 a[28:31], v[20:23], a[108:111], a[28:31]
    v_mfma_f32_16x16x32_bf16 a[60:63], v[20:23], a[116:119], a[60:63]
    v_mfma_f32_16x16x32_bf16 a[92:95], v[20:23], a[124:127], a[92:95]
    ds_read_b64_tr_b16 v[40:41], v8 offset:256
    ds_read_b64_tr_b16 v[42:43], v8 offset:1296
    s_waitcnt lgkmcnt(14)
    v_mfma_f32_16x16x32_bf16 a[96:99], v[24:27], a[132:135], a[96:99]
    ds_read_b64_tr_b16 v[44:45], v8 offset:288
    ds_read_b64_tr_b16 v[46:47], v8 offset:1328
    s_waitcnt lgkmcnt(14)
    v_mfma_f32_16x16x32_bf16 a[100:103], v[28:31], a[132:135], a[100:103]
    s_waitcnt lgkmcnt(0)
    s_barrier
    ds_read_b128 a[160:163], v11 offset:2176
    ds_read_b128 a[164:167], v11 offset:2240
    ds_read_b64_tr_b16 v[16:17], v8 offset:512
    ds_read_b64_tr_b16 v[18:19], v8 offset:1552
    v_mfma_f32_16x16x32_bf16 a[0:3], v[32:35], a[136:139], a[0:3]
    v_mfma_f32_16x16x32_bf16 a[32:35], v[32:35], a[144:147], a[32:35]
    v_mfma_f32_16x16x32_bf16 a[64:67], v[32:35], a[152:155], a[64:67]
    s_cmp_lg_u32 s28, 3
    s_cbranch_scc1 L_x12_2
    s_mov_b32 s54, 246016
    s_mov_b32 m0, 67712
    s_nop 0
    buffer_load_dwordx4 v6, s[8:11], s54 offen lds
    s_mov_b32 s54, 256256
    s_mov_b32 m0, 68800
    s_nop 0
    buffer_load_dwordx4 v6, s[8:11], s54 offen lds
L_x12_2:
    ds_read_b64_tr_b16 v[20:21], v8 offset:544
    ds_read_b64_tr_b16 v[22:23], v8 offset:1584
    v_mfma_f32_16x16x32_bf16 a[4:7], v[36:39], a[136:139], a[4:7]
    v_mfma_f32_16x16x32_bf16 a[36:39], v[36:39], a[144:147], a[36:39]
    v_mfma_f32_16x16x32_bf16 a[68:71], v[36:39], a[152:155], a[68:71]
    s_add_u32 s54, s33, 256
    s_add_u32 m0, s34, 0
    s_nop 0
    buffer_load_dwordx4 v6, s[8:11], s54 offen lds
    ds_read_b64_tr_b16 v[24:25], v8 offset:768
    ds_read_b64_tr_b16 v[26:27], v8 offset:1808
    v_mfma_f32_16x16x32_bf16 a[8:11], v[40:43], a[136:139], a[8:11]
    v_mfma_f32_16x16x32_bf16 a[40:43], v[40:43], a[144:147], a[40:43]
    v_mfma_f32_16x16x32_bf16 a[72:75], v[40:43], a[152:155], a[72:75]
    s_add_u32 s54, s33, 10496
    s_add_u32 m0, s34, 1088
    s_nop 0
    buffer_load_dwordx4 v6, s[8:11], s54 offen lds
    ds_read_b64_tr_b16 v[28:29], v8 offset:800
    ds_read_b64_tr_b16 v[30:31], v8 offset:1840
    v_mfma_f32_16x16x32_bf16 a[12:15], v[44:47], a[136:139], a[12:15]
    v_mfma_f32_16x16x32_bf16 a[44:47], v[44:47], a[144:147], a[44:47]
    v_mfma_f32_16x16x32_bf16 a[76:79], v[44:47], a[152:155], a[76:79]
    s_add_u32 s54, s33, 20736
    s_add_u32 m0, s34, 2176
    s_nop 0
    buffer_load_dwordx4 v6, s[8:11], s54 offen lds
    ds_read_b64_tr_b16 v[32:33], v9 offset:0
    ds_read_b64_tr_b16 v[34:35], v9 offset:1040
    s_waitcnt lgkmcnt(8)
    v_mfma_f32_16x16x32_bf16 a[16:19], v[16:19], a[136:139], a[16:19]
    v_mfma_f32_16x16x32_bf16 a[48:51], v[16:19], a[144:147], a[48:51]
    v_mfma_f32_16x16x32_bf16 a[80:83], v[16:19], a[152:155], a[80:83]
    s_add_u32 s54, s33, 30976
    s_add_u32 m0, s34, 3264
    s_nop 0
    buffer_load_dwordx4 v6, s[8:11], s54 offen lds
    ds_read_b64_tr_b16 v[36:37], v9 offset:32
    ds_read_b64_tr_b16 v[38:39], v9 offset:1072
    s_waitcnt lgkmcnt(8)
    v_mfma_f32_16x16x32_bf16 a[20:23], v[20:23], a[136:139], a[20:23]
    v_mfma_f32_16x16x32_bf16 a[52:55], v[20:23], a[144:147], a[52:55]
    v_mfma_f32_16x16x32_bf16 a[84:87], v[20:23], a[152:155], a[84:87]
    s_add_u32 s54, s33, 41216
    s_add_u32 m0, s34, 4352
    s_nop 0
    buffer_load_dwordx4 v6, s[8:11], s54 offen lds
    v_add_u32 v8, 51072, v7
    v_add_u32 v9, s35, v8
    ds_read_b64_tr_b16 v[40:41], v8 offset:0
    ds_read_b64_tr_b16 v[42:43], v8 offset:1040
    s_waitcnt lgkmcnt(8)
    v_mfma_f32_16x16x32_bf16 a[24:27], v[24:27], a[136:139], a[24:27]
    v_mfma_f32_16x16x32_bf16 a[56:59], v[24:27], a[144:147], a[56:59]
    v_mfma_f32_16x16x32_bf16 a[88:91], v[24:27], a[152:155], a[88:91]
    s_add_u32 s54, s33, 51456
    s_add_u32 m0, s34, 5440
    s_nop 0
    buffer_load_dwordx4 v6, s[8:11], s54 offen lds
    ds_read_b64_tr_b16 v[44:45], v8 offset:32
    ds_read_b64_tr_b16 v[46:47], v8 offset:1072
    s_waitcnt lgkmcnt(8)
    v_mfma_f32_16x16x32_bf16 a[28:31], v[28:31], a[136:139], a[28:31]
    v_mfma_f32_16x16x32_bf16 a[60:63], v[28:31], a[144:147], a[60:63]
    v_mfma_f32_16x16x32_bf16 a[92:95], v[28:31], a[152:155], a[92:95]
    s_mov_b32 s55, 1572864
    s_add_u32 m0, s31, 34432
    s_nop 0
    buffer_load_dwordx4 v5, s[12:15], s55 offen lds
    ds_read_b64_tr_b16 v[16:17], v8 offset:256
    ds_read_b64_tr_b16 v[18:19], v8 offset:1296
    s_waitcnt lgkmcnt(8)
    v_mfma_f32_16x16x32_bf16 a[96:99], v[32:35], a[160:163], a[96:99]
    s_mov_b32 s55, 1605632
    s_add_u32 m0, s31, 35472
    s_nop 0
    buffer_load_dwordx4 v5, s[12:15], s55 offen lds
    ds_read_b64_tr_b16 v[20:21], v8 offset:288
    ds_read_b64_tr_b16 v[22:23], v8 offset:1328
    s_waitcnt lgkmcnt(8)
    v_mfma_f32_16x16x32_bf16 a[100:103], v[36:39], a[160:163], a[100:103]
    s_waitcnt vmcnt(10)
    s_barrier
    ds_read_b64_tr_b16 v[24:25], v8 offset:512
    ds_read_b64_tr_b16 v[26:27], v8 offset:1552
    s_waitcnt lgkmcnt(8)
    v_mfma_f32_16x16x32_bf16 a[0:3], v[40:43], a[140:143], a[0:3]
    v_mfma_f32_16x16x32_bf16 a[32:35], v[40:43], a[148:151], a[32:35]
    v_mfma_f32_16x16x32_bf16 a[64:67], v[40:43], a[156:159], a[64:67]
    s_mov_b32 s55, 1835008
    s_add_u32 m0, s31, 42752
    s_nop 0
    buffer_load_dwordx4 v5, s[12:15], s55 offen lds
    ds_read_b64_tr_b16 v[28:29], v8 offset:544
    ds_read_b64_tr_b16 v[30:31], v8 offset:1584
    s_waitcnt lgkmcnt(8)
    v_mfma_f32_16x16x32_bf16 a[4:7], v[44:47], a[140:143], a[4:7]
    v_mfma_f32_16x16x32_bf16 a[36:39], v[44:47], a[148:151], a[36:39]
    v_mfma_f32_16x16x32_bf16 a[68:71], v[44:47], a[156:159], a[68:71]
    s_mov_b32 s55, 1867776
    s_add_u32 m0, s31, 43792
    s_nop 0
    buffer_load_dwordx4 v5, s[12:15], s55 offen lds
    ds_read_b64_tr_b16 v[32:33], v8 offset:768
    ds_read_b64_tr_b16 v[34:35], v8 offset:1808
    s_waitcnt lgkmcnt(8)
    v_mfma_f32_16x16x32_bf16 a[8:11], v[16:19], a[140:143], a[8:11]
    v_mfma_f32_16x16x32_bf16 a[40:43], v[16:19], a[148:151], a[40:43]
    v_mfma_f32_16x16x32_bf16 a[72:75], v[16:19], a[156:159], a[72:75]
    ds_read_b64_tr_b16 v[36:37], v8 offset:800
    ds_read_b64_tr_b16 v[38:39], v8 offset:1840
    s_waitcnt lgkmcnt(8)
    v_mfma_f32_16x16x32_bf16 a[12:15], v[20:23], a[140:143], a[12:15]
    v_mfma_f32_16x16x32_bf16 a[44:47], v[20:23], a[148:151], a[44:47]
    v_mfma_f32_16x16x32_bf16 a[76:79], v[20:23], a[156:159], a[76:79]
    ds_read_b64_tr_b16 v[40:41], v9 offset:0
    ds_read_b64_tr_b16 v[42:43], v9 offset:1040
    s_waitcnt lgkmcnt(8)
    v_mfma_f32_16x16x32_bf16 a[16:19], v[24:27], a[140:143], a[16:19]
    v_mfma_f32_16x16x32_bf16 a[48:51], v[24:27], a[148:151], a[48:51]
    v_mfma_f32_16x16x32_bf16 a[80:83], v[24:27], a[156:159], a[80:83]
    ds_read_b64_tr_b16 v[44:45], v9 offset:32
    ds_read_b64_tr_b16 v[46:47], v9 offset:1072
    s_waitcnt lgkmcnt(8)
    v_mfma_f32_16x16x32_bf16 a[20:23], v[28:31], a[140:143], a[20:23]
    v_mfma_f32_16x16x32_bf16 a[52:55], v[28:31], a[148:151], a[52:55]
    v_mfma_f32_16x16x32_bf16 a[84:87], v[28:31], a[156:159], a[84:87]
    v_add_u32 v8, 59392, v7
    v_add_u32 v9, s35, v8
    ds_read_b64_tr_b16 v[16:17], v8 offset:0
    ds_read_b64_tr_b16 v[18:19], v8 offset:1040
    s_waitcnt lgkmcnt(8)
    v_mfma_f32_16x16x32_bf16 a[24:27], v[32:35], a[140:143], a[24:27]
    v_mfma_f32_16x16x32_bf16 a[56:59], v[32:35], a[148:151], a[56:59]
    v_mfma_f32_16x16x32_bf16 a[88:91], v[32:35], a[156:159], a[88:91]
    ds_read_b64_tr_b16 v[20:21], v8 offset:32
    ds_read_b64_tr_b16 v[22:23], v8 offset:1072
    s_waitcnt vmcnt(4)
    ds_read_b128 a[104:107], v10 offset:0
    ds_read_b128 a[108:111], v10 offset:64
    ds_read_b128 a[112:115], v10 offset:2176
    ds_read_b128 a[116:119], v10 offset:2240
    ds_read_b128 a[120:123], v10 offset:4352
    ds_read_b128 a[124:127], v10 offset:4416
    s_waitcnt lgkmcnt(14)
    v_mfma_f32_16x16x32_bf16 a[28:31], v[36:39], a[140:143], a[28:31]
    v_mfma_f32_16x16x32_bf16 a[60:63], v[36:39], a[148:151], a[60:63]
    v_mfma_f32_16x16x32_bf16 a[92:95], v[36:39], a[156:159], a[92:95]
    ds_read_b64_tr_b16 v[24:25], v8 offset:256
    ds_read_b64_tr_b16 v[26:27], v8 offset:1296
    s_waitcnt lgkmcnt(14)
    v_mfma_f32_16x16x32_bf16 a[96:99], v[40:43], a[164:167], a[96:99]
    ds_read_b64_tr_b16 v[28:29], v8 offset:288
    ds_read_b64_tr_b16 v[30:31], v8 offset:1328
    s_waitcnt lgkmcnt(14)
    v_mfma_f32_16x16x32_bf16 a[100:103], v[44:47], a[164:167], a[100:103]
    s_waitcnt lgkmcnt(0)
    s_barrier
    ds_read_b128 a[128:131], v11 offset:0
    ds_read_b128 a[132:135], v11 offset:64
    ds_read_b64_tr_b16 v[32:33], v8 offset:512
    ds_read_b64_tr_b16 v[34:35], v8 offset:1552
    v_mfma_f32_16x16x32_bf16 a[0:3], v[16:19], a[104:107], a[0:3]
    v_mfma_f32_16x16x32_bf16 a[32:35], v[16:19], a[112:115], a[32:35]
    v_mfma_f32_16x16x32_bf16 a[64:67], v[16:19], a[120:123], a[64:67]
    s_cmp_lg_u32 s28, 3
    s_cbranch_scc1 L_x12_3
    s_mov_b32 s54, 246144
    s_mov_b32 m0, 69888
    s_nop 0
    buffer_load_dwordx4 v6, s[8:11], s54 offen lds
    s_mov_b32 s54, 256384
    s_mov_b32 m0, 70976
    s_nop 0
    buffer_load_dwordx4 v6, s[8:11], s54 offen lds
L_x12_3:
    ds_read_b64_tr_b16 v[36:37], v8 offset:544
    ds_read_b64_tr_b16 v[38:39], v8 offset:1584
    v_mfma_f32_16x16x32_bf16 a[4:7], v[20:23], a[104:107], a[4:7]
    v_mfma_f32_16x16x32_bf16 a[36:39], v[20:23], a[112:115], a[36:39]
    v_mfma_f32_16x16x32_bf16 a[68:71], v[20:23], a[120:123], a[68:71]
    s_add_u32 s54, s33, 384
    s_add_u32 m0, s34, 0
    s_nop 0
    buffer_load_dwordx4 v6, s[8:11], s54 offen lds
    ds_read_b64_tr_b16 v[40:41], v8 offset:768
    ds_read_b64_tr_b16 v[42:43], v8 offset:1808
    v_mfma_f32_16x16x32_bf16 a[8:11], v[24:27], a[104:107], a[8:11]
    v_mfma_f32_16x16x32_bf16 a[40:43], v[24:27], a[112:115], a[40:43]
    v_mfma_f32_16x16x32_bf16 a[72:75], v[24:27], a[120:123], a[72:75]
    s_add_u32 s54, s33, 10624
    s_add_u32 m0, s34, 1088
    s_nop 0
    buffer_load_dwordx4 v6, s[8:11], s54 offen lds
    ds_read_b64_tr_b16 v[44:45], v8 offset:800
    ds_read_b64_tr_b16 v[46:47], v8 offset:1840
    v_mfma_f32_16x16x32_bf16 a[12:15], v[28:31], a[104:107], a[12:15]
    v_mfma_f32_16x16x32_bf16 a[44:47], v[28:31], a[112:115], a[44:47]
    v_mfma_f32_16x16x32_bf16 a[76:79], v[28:31], a[120:123], a[76:79]
    s_add_u32 s54, s33, 20864
    s_add_u32 m0, s34, 2176
    s_nop 0
    buffer_load_dwordx4 v6, s[8:11], s54 offen lds
    ds_read_b64_tr_b16 v[16:17], v9 offset:0
    ds_read_b64_tr_b16 v[18:19], v9 offset:1040
    s_waitcnt lgkmcnt(8)
    v_mfma_f32_16x16x32_bf16 a[16:19], v[32:35], a[104:107], a[16:19]
    v_mfma_f32_16x16x32_bf16 a[48:51], v[32:35], a[112:115], a[48:51]
    v_mfma_f32_16x16x32_bf16 a[80:83], v[32:35], a[120:123], a[80:83]
    s_add_u32 s54, s33, 31104
    s_add_u32 m0, s34, 3264
    s_nop 0
    buffer_load_dwordx4 v6, s[8:11], s54 offen lds
    ds_read_b64_tr_b16 v[20:21], v9 offset:32
    ds_read_b64_tr_b16 v[22:23], v9 offset:1072
    s_waitcnt lgkmcnt(8)
    v_mfma_f32_16x16x32_bf16 a[20:23], v[36:39], a[104:107], a[20:23]
    v_mfma_f32_16x16x32_bf16 a[52:55], v[36:39], a[112:115], a[52:55]
    v_mfma_f32_16x16x32_bf16 a[84:87], v[36:39], a[120:123], a[84:87]
    s_add_u32 s54, s33, 41344
    s_add_u32 m0, s34, 4352
    s_nop 0
    buffer_load_dwordx4 v6, s[8:11], s54 offen lds
    v_add_u32 v8, 26112, v7
    v_add_u32 v9, s35, v8
    ds_read_b64_tr_b16 v[24:25], v8 offset:0
    ds_read_b64_tr_b16 v[26:27], v8 offset:1040
    s_waitcnt lgkmcnt(8)
    v_mfma_f32_16x16x32_bf16 a[24:27], v[40:43], a[104:107], a[24:27]
    v_mfma_f32_16x16x32_bf16 a[56:59], v[40:43], a[112:115], a[56:59]
    v_mfma_f32_16x16x32_bf16 a[88:91], v[40:43], a[120:123], a[88:91]
    s_add_u32 s54, s33, 51584
    s_add_u32 m0, s34, 5440
    s_nop 0
    buffer_load_dwordx4 v6, s[8:11], s54 offen lds
    ds_read_b64_tr_b16 v[28:29], v8 offset:32
    ds_read_b64_tr_b16 v[30:31], v8 offset:1072
    s_waitcnt lgkmcnt(8)
    v_mfma_f32_16x16x32_bf16 a[28:31], v[44:47], a[104:107], a[28:31]
    v_mfma_f32_16x16x32_bf16 a[60:63], v[44:47], a[112:115], a[60:63]
    v_mfma_f32_16x16x32_bf16 a[92:95], v[44:47], a[120:123], a[92:95]
    s_mov_b32 s55, 2097152
    s_add_u32 m0, s31, 51072
    s_nop 0
    buffer_load_dwordx4 v5, s[12:15], s55 offen lds
    ds_read_b64_tr_b16 v[32:33], v8 offset:256
    ds_read_b64_tr_b16 v[34:35], v8 offset:1296
    s_waitcnt lgkmcnt(8)
    v_mfma_f32_16x16x32_bf16 a[96:99], v[16:19], a[128:131], a[96:99]
    s_mov_b32 s55, 2129920
    s_add_u32 m0, s31, 52112
    s_nop 0
    buffer_load_dwordx4 v5, s[12:15], s55 offen lds
    ds_read_b64_tr_b16 v[36:37], v8 offset:288
    ds_read_b64_tr_b16 v[38:39], v8 offset:1328
    s_waitcnt lgkmcnt(8)
    v_mfma_f32_16x16x32_bf16 a[100:103], v[20:23], a[128:131], a[100:103]
    s_waitcnt vmcnt(10)
    s_barrier
    ds_read_b64_tr_b16 v[40:41], v8 offset:512
    ds_read_b64_tr_b16 v[42:43], v8 offset:1552
    s_waitcnt lgkmcnt(8)
    v_mfma_f32_16x16x32_bf16 a[0:3], v[24:27], a[108:111], a[0:3]
    v_mfma_f32_16x16x32_bf16 a[32:35], v[24:27], a[116:119], a[32:35]
    v_mfma_f32_16x16x32_bf16 a[64:67], v[24:27], a[124:127], a[64:67]
    s_mov_b32 s55, 2359296
    s_add_u32 m0, s31, 59392
    s_nop 0
    buffer_load_dwordx4 v5, s[12:15], s55 offen lds
    ds_read_b64_tr_b16 v[44:45], v8 offset:544
    ds_read_b64_tr_b16 v[46:47], v8 offset:1584
    s_waitcnt lgkmcnt(8)
    v_mfma_f32_16x16x32_bf16 a[4:7], v[28:31], a[108:111], a[4:7]
    v_mfma_f32_16x16x32_bf16 a[36:39], v[28:31], a[116:119], a[36:39]
    v_mfma_f32_16x16x32_bf16 a[68:71], v[28:31], a[124:127], a[68:71]
    s_mov_b32 s55, 2392064
    s_add_u32 m0, s31, 60432
    s_nop 0
    buffer_load_dwordx4 v5, s[12:15], s55 offen lds
    ds_read_b64_tr_b16 v[16:17], v8 offset:768
    ds_read_b64_tr_b16 v[18:19], v8 offset:1808
    s_waitcnt lgkmcnt(8)
    v_mfma_f32_16x16x32_bf16 a[8:11], v[32:35], a[108:111], a[8:11]
    v_mfma_f32_16x16x32_bf16 a[40:43], v[32:35], a[116:119], a[40:43]
    v_mfma_f32_16x16x32_bf16 a[72:75], v[32:35], a[124:127], a[72:75]
    ds_read_b64_tr_b16 v[20:21], v8 offset:800
    ds_read_b64_tr_b16 v[22:23], v8 offset:1840
    s_waitcnt lgkmcnt(8)
    v_mfma_f32_16x16x32_bf16 a[12:15], v[36:39], a[108:111], a[12:15]
    v_mfma_f32_16x16x32_bf16 a[44:47], v[36:39], a[116:119], a[44:47]
    v_mfma_f32_16x16x32_bf16 a[76:79], v[36:39], a[124:127], a[76:79]
    ds_read_b64_tr_b16 v[24:25], v9 offset:0
    ds_read_b64_tr_b16 v[26:27], v9 offset:1040
    s_waitcnt lgkmcnt(8)
    v_mfma_f32_16x16x32_bf16 a[16:19], v[40:43], a[108:111], a[16:19]
    v_mfma_f32_16x16x32_bf16 a[48:51], v[40:43], a[116:119], a[48:51]
    v_mfma_f32_16x16x32_bf16 a[80:83], v[40:43], a[124:127], a[80:83]
    ds_read_b64_tr_b16 v[28:29], v9 offset:32
    ds_read_b64_tr_b16 v[30:31], v9 offset:1072
    s_waitcnt lgkmcnt(8)
    v_mfma_f32_16x16x32_bf16 a[20:23], v[44:47], a[108:111], a[20:23]
    v_mfma_f32_16x16x32_bf16 a[52:55], v[44:47], a[116:119], a[52:55]
    v_mfma_f32_16x16x32_bf16 a[84:87], v[44:47], a[124:127], a[84:87]
    v_add_u32 v8, 34432, v7
    v_add_u32 v9, s35, v8
    ds_read_b64_tr_b16 v[32:33], v8 offset:0
    ds_read_b64_tr_b16 v[34:35], v8 offset:1040
    s_waitcnt lgkmcnt(8)
    v_mfma_f32_16x16x32_bf16 a[24:27], v[16:19], a[108:111], a[24:27]
    v_mfma_f32_16x16x32_bf16 a[56:59], v[16:19], a[116:119], a[56:59]
    v_mfma_f32_16x16x32_bf16 a[88:91], v[16:19], a[124:127], a[88:91]
    ds_read_b64_tr_b16 v[36:37], v8 offset:32
    ds_read_b64_tr_b16 v[38:39], v8 offset:1072
    s_waitcnt vmcnt(4)
    ds_read_b128 a[136:139], v10 offset:0
    ds_read_b128 a[140:143], v10 offset:64
    ds_read_b128 a[144:147], v10 offset:2176
    ds_read_b128 a[148:151], v10 offset:2240
    ds_read_b128 a[152:155], v10 offset:4352
    ds_read_b128 a[156:159], v10 offset:4416
    s_waitcnt lgkmcnt(14)
    v_mfma_f32_16x16x32_bf16 a[28:31], v[20:23], a[108:111], a[28:31]
    v_mfma_f32_16x16x32_bf16 a[60:63], v[20:23], a[116:119], a[60:63]
    v_mfma_f32_16x16x32_bf16 a[92:95], v[20:23], a[124:127], a[92:95]
    ds_read_b64_tr_b16 v[40:41], v8 offset:256
    ds_read_b64_tr_b16 v[42:43], v8 offset:1296
    s_waitcnt lgkmcnt(14)
    v_mfma_f32_16x16x32_bf16 a[96:99], v[24:27], a[132:135], a[96:99]
    ds_read_b64_tr_b16 v[44:45], v8 offset:288
    ds_read_b64_tr_b16 v[46:47], v8 offset:1328
    s_waitcnt lgkmcnt(14)
    v_mfma_f32_16x16x32_bf16 a[100:103], v[28:31], a[132:135], a[100:103]
    s_waitcnt lgkmcnt(0)
    s_barrier
    ds_read_b128 a[160:163], v11 offset:2176
    ds_read_b128 a[164:167], v11 offset:2240
    ds_read_b64_tr_b16 v[16:17], v8 offset:512
    ds_read_b64_tr_b16 v[18:19], v8 offset:1552
    v_mfma_f32_16x16x32_bf16 a[0:3], v[32:35], a[136:139], a[0:3]
    v_mfma_f32_16x16x32_bf16 a[32:35], v[32:35], a[144:147], a[32:35]
    v_mfma_f32_16x16x32_bf16 a[64:67], v[32:35], a[152:155], a[64:67]
    s_cmp_lg_u32 s28, 3
    s_cbranch_scc1 L_x12_4
    s_mov_b32 s54, 246272
    s_mov_b32 m0, 67712
    s_nop 0
    buffer_load_dwordx4 v6, s[8:11], s54 offen lds
    s_mov_b32 s54, 256512
    s_mov_b32 m0, 68800
    s_nop 0
    buffer_load_dwordx4 v6, s[8:11], s54 offen lds
L_x12_4:
    ds_read_b64_tr_b16 v[20:21], v8 offset:544
    ds_read_b64_tr_b16 v[22:23], v8 offset:1584
    v_mfma_f32_16x16x32_bf16 a[4:7], v[36:39], a[136:139], a[4:7]
    v_mfma_f32_16x16x32_bf16 a[36:39], v[36:39], a[144:147], a[36:39]
    v_mfma_f32_16x16x32_bf16 a[68:71], v[36:39], a[152:155], a[68:71]
    s_add_u32 s54, s33, 512
    s_add_u32 m0, s34, 0
    s_nop 0
    buffer_load_dwordx4 v6, s[8:11], s54 offen lds
    ds_read_b64_tr_b16 v[24:25], v8 offset:768
    ds_read_b64_tr_b16 v[26:27], v8 offset:1808
    v_mfma_f32_16x16x32_bf16 a[8:11], v[40:43], a[136:139], a[8:11]
    v_mfma_f32_16x16x32_bf16 a[40:43], v[40:43], a[144:147], a[40:43]
    v_mfma_f32_16x16x32_bf16 a[72:75], v[40:43], a[152:155], a[72:75]
    s_add_u32 s54, s33, 10752
    s_add_u32 m0, s34, 1088
    s_nop 0
    buffer_load_dwordx4 v6, s[8:11], s54 offen lds
    ds_read_b64_tr_b16 v[28:29], v8 offset:800
    ds_read_b64_tr_b16 v[30:31], v8 offset:1840
    v_mfma_f32_16x16x32_bf16 a[12:15], v[44:47], a[136:139], a[12:15]
    v_mfma_f32_16x16x32_bf16 a[44:47], v[44:47], a[144:147], a[44:47]
    v_mfma_f32_16x16x32_bf16 a[76:79], v[44:47], a[152:155], a[76:79]
    s_add_u32 s54, s33, 20992
    s_add_u32 m0, s34, 2176
    s_nop 0
    buffer_load_dwordx4 v6, s[8:11], s54 offen lds
    ds_read_b64_tr_b16 v[32:33], v9 offset:0
    ds_read_b64_tr_b16 v[34:35], v9 offset:1040
    s_waitcnt lgkmcnt(8)
    v_mfma_f32_16x16x32_bf16 a[16:19], v[16:19], a[136:139], a[16:19]
    v_mfma_f32_16x16x32_bf16 a[48:51], v[16:19], a[144:147], a[48:51]
    v_mfma_f32_16x16x32_bf16 a[80:83], v[16:19], a[152:155], a[80:83]
    s_add_u32 s54, s33, 31232
    s_add_u32 m0, s34, 3264
    s_nop 0
    buffer_load_dwordx4 v6, s[8:11], s54 offen lds
    ds_read_b64_tr_b16 v[36:37], v9 offset:32
    ds_read_b64_tr_b16 v[38:39], v9 offset:1072
    s_waitcnt lgkmcnt(8)
    v_mfma_f32_16x16x32_bf16 a[20:23], v[20:23], a[136:139], a[20:23]
    v_mfma_f32_16x16x32_bf16 a[52:55], v[20:23], a[144:147], a[52:55]
    v_mfma_f32_16x16x32_bf16 a[84:87], v[20:23], a[152:155], a[84:87]
    s_add_u32 s54, s33, 41472
    s_add_u32 m0, s34, 4352
    s_nop 0
    buffer_load_dwordx4 v6, s[8:11], s54 offen lds
    v_add_u32 v8, 42752, v7
    v_add_u32 v9, s35, v8
    ds_read_b64_tr_b16 v[40:41], v8 offset:0
    ds_read_b64_tr_b16 v[42:43], v8 offset:1040
    s_waitcnt lgkmcnt(8)
    v_mfma_f32_16x16x32_bf16 a[24:27], v[24:27], a[136:139], a[24:27]
    v_mfma_f32_16x16x32_bf16 a[56:59], v[24:27], a[144:147], a[56:59]
    v_mfma_f32_16x16x32_bf16 a[88:91], v[24:27], a[152:155], a[88:91]
    s_add_u32 s54, s33, 51712
    s_add_u32 m0, s34, 5440
    s_nop 0
    buffer_load_dwordx4 v6, s[8:11], s54 offen lds
    ds_read_b64_tr_b16 v[44:45], v8 offset:32
    ds_read_b64_tr_b16 v[46:47], v8 offset:1072
    s_waitcnt lgkmcnt(8)
    v_mfma_f32_16x16x32_bf16 a[28:31], v[28:31], a[136:139], a[28:31]
    v_mfma_f32_16x16x32_bf16 a[60:63], v[28:31], a[144:147], a[60:63]
    v_mfma_f32_16x16x32_bf16 a[92:95], v[28:31], a[152:155], a[92:95]
    s_mov_b32 s55, 2621440
    s_add_u32 m0, s31, 26112
    s_nop 0
    buffer_load_dwordx4 v5, s[12:15], s55 offen lds
    ds_read_b64_tr_b16 v[16:17], v8 offset:256
    ds_read_b64_tr_b16 v[18:19], v8 offset:1296
    s_waitcnt lgkmcnt(8)
    v_mfma_f32_16x16x32_bf16 a[96:99], v[32:35], a[160:163], a[96:99]
    s_mov_b32 s55, 2654208
    s_add_u32 m0, s31, 27152
    s_nop 0
    buffer_load_dwordx4 v5, s[12:15], s55 offen lds
    ds_read_b64_tr_b16 v[20:21], v8 offset:288
    ds_read_b64_tr_b16 v[22:23], v8 offset:1328
    s_waitcnt lgkmcnt(8)
    v_mfma_f32_16x16x32_bf16 a[100:103], v[36:39], a[160:163], a[100:103]
    s_waitcnt vmcnt(10)
    s_barrier
    ds_read_b64_tr_b16 v[24:25], v8 offset:512
    ds_read_b64_tr_b16 v[26:27], v8 offset:1552
    s_waitcnt lgkmcnt(8)
    v_mfma_f32_16x16x32_bf16 a[0:3], v[40:43], a[140:143], a[0:3]
    v_mfma_f32_16x16x32_bf16 a[32:35], v[40:43], a[148:151], a[32:35]
    v_mfma_f32_16x16x32_bf16 a[64:67], v[40:43], a[156:159], a[64:67]
    s_mov_b32 s55, 2883584
    s_add_u32 m0, s31, 34432
    s_nop 0
    buffer_load_dwordx4 v5, s[12:15], s55 offen lds
    ds_read_b64_tr_b16 v[28:29], v8 offset:544
    ds_read_b64_tr_b16 v[30:31], v8 offset:1584
    s_waitcnt lgkmcnt(8)
    v_mfma_f32_16x16x32_bf16 a[4:7], v[44:47], a[140:143], a[4:7]
    v_mfma_f32_16x16x32_bf16 a[36:39], v[44:47], a[148:151], a[36:39]
    v_mfma_f32_16x16x32_bf16 a[68:71], v[44:47], a[156:159], a[68:71]
    s_mov_b32 s55, 2916352
    s_add_u32 m0, s31, 35472
    s_nop 0
    buffer_load_dwordx4 v5, s[12:15], s55 offen lds
    ds_read_b64_tr_b16 v[32:33], v8 offset:768
    ds_read_b64_tr_b16 v[34:35], v8 offset:1808
    s_waitcnt lgkmcnt(8)
    v_mfma_f32_16x16x32_bf16 a[8:11], v[16:19], a[140:143], a[8:11]
    v_mfma_f32_16x16x32_bf16 a[40:43], v[16:19], a[148:151], a[40:43]
    v_mfma_f32_16x16x32_bf16 a[72:75], v[16:19], a[156:159], a[72:75]
    ds_read_b64_tr_b16 v[36:37], v8 offset:800
    ds_read_b64_tr_b16 v[38:39], v8 offset:1840
    s_waitcnt lgkmcnt(8)
    v_mfma_f32_16x16x32_bf16 a[12:15], v[20:23], a[140:143], a[12:15]
    v_mfma_f32_16x16x32_bf16 a[44:47], v[20:23], a[148:151], a[44:47]
    v_mfma_f32_16x16x32_bf16 a[76:79], v[20:23], a[156:159], a[76:79]
    ds_read_b64_tr_b16 v[40:41], v9 offset:0
    ds_read_b64_tr_b16 v[42:43], v9 offset:1040
    s_waitcnt lgkmcnt(8)
    v_mfma_f32_16x16x32_bf16 a[16:19], v[24:27], a[140:143], a[16:19]
    v_mfma_f32_16x16x32_bf16 a[48:51], v[24:27], a[148:151], a[48:51]
    v_mfma_f32_16x16x32_bf16 a[80:83], v[24:27], a[156:159], a[80:83]
    ds_read_b64_tr_b16 v[44:45], v9 offset:32
    ds_read_b64_tr_b16 v[46:47], v9 offset:1072
    s_waitcnt lgkmcnt(8)
    v_mfma_f32_16x16x32_bf16 a[20:23], v[28:31], a[140:143], a[20:23]
    v_mfma_f32_16x16x32_bf16 a[52:55], v[28:31], a[148:151], a[52:55]
    v_mfma_f32_16x16x32_bf16 a[84:87], v[28:31], a[156:159], a[84:87]
    v_add_u32 v8, 51072, v7
    v_add_u32 v9, s35, v8
    ds_read_b64_tr_b16 v[16:17], v8 offset:0
    ds_read_b64_tr_b16 v[18:19], v8 offset:1040
    s_waitcnt lgkmcnt(8)
    v_mfma_f32_16x16x32_bf16 a[24:27], v[32:35], a[140:143], a[24:27]
    v_mfma_f32_16x16x32_bf16 a[56:59], v[32:35], a[148:151], a[56:59]
    v_mfma_f32_16x16x32_bf16 a[88:91], v[32:35], a[156:159], a[88:91]
    ds_read_b64_tr_b16 v[20:21], v8 offset:32
    ds_read_b64_tr_b16 v[22:23], v8 offset:1072
    s_waitcnt vmcnt(4)
    ds_read_b128 a[104:107], v10 offset:0
    ds_read_b128 a[108:111], v10 offset:64
    ds_read_b128 a[112:115], v10 offset:2176
    ds_read_b128 a[116:119], v10 offset:2240
    ds_read_b128 a[120:123], v10 offset:4352
    ds_read_b128 a[124:127], v10 offset:4416
    s_waitcnt lgkmcnt(14)
    v_mfma_f32_16x16x32_bf16 a[28:31], v[36:39], a[140:143], a[28:31]
    v_mfma_f32_16x16x32_bf16 a[60:63], v[36:39], a[148:151], a[60:63]
    v_mfma_f32_16x16x32_bf16 a[92:95], v[36:39], a[156:159], a[92:95]
    ds_read_b64_tr_b16 v[24:25], v8 offset:256
    ds_read_b64_tr_b16 v[26:27], v8 offset:1296
    s_waitcnt lgkmcnt(14)
    v_mfma_f32_16x16x32_bf16 a[96:99], v[40:43], a[164:167], a[96:99]
    ds_read_b64_tr_b16 v[28:29], v8 offset:288
    ds_read_b64_tr_b16 v[30:31], v8 offset:1328
    s_waitcnt lgkmcnt(14)
    v_mfma_f32_16x16x32_bf16 a[100:103], v[44:47], a[164:167], a[100:103]
    s_waitcnt lgkmcnt(0)
    s_barrier
    ds_read_b128 a[128:131], v11 offset:0
    ds_read_b128 a[132:135], v11 offset:64
    ds_read_b64_tr_b16 v[32:33], v8 offset:512
    ds_read_b64_tr_b16 v[34:35], v8 offset:1552
    v_mfma_f32_16x16x32_bf16 a[0:3], v[16:19], a[104:107], a[0:3]
    v_mfma_f32_16x16x32_bf16 a[32:35], v[16:19], a[112:115], a[32:35]
    v_mfma_f32_16x16x32_bf16 a[64:67], v[16:19], a[120:123], a[64:67]
    s_cmp_lg_u32 s28, 3
    s_cbranch_scc1 L_x12_5
    s_mov_b32 s54, 246400
    s_mov_b32 m0, 69888
    s_nop 0
    buffer_load_dwordx4 v6, s[8:11], s54 offen lds
    s_mov_b32 s54, 256640
    s_mov_b32 m0, 70976
    s_nop 0
    buffer_load_dwordx4 v6, s[8:11], s54 offen lds
L_x12_5:
    ds_read_b64_tr_b16 v[36:37], v8 offset:544
    ds_read_b64_tr_b16 v[38:39], v8 offset:1584
    v_mfma_f32_16x16x32_bf16 a[4:7], v[20:23], a[104:107], a[4:7]
    v_mfma_f32_16x16x32_bf16 a[36:39], v[20:23], a[112:115], a[36:39]
    v_mfma_f32_16x16x32_bf16 a[68:71], v[20:23], a[120:123], a[68:71]
    s_add_u32 s54, s33, 640
    s_add_u32 m0, s34, 0
    s_nop 0
    buffer_load_dwordx4 v6, s[8:11], s54 offen lds
    ds_read_b64_tr_b16 v[40:41], v8 offset:768
    ds_read_b64_tr_b16 v[42:43], v8 offset:1808
    v_mfma_f32_16x16x32_bf16 a[8:11], v[24:27], a[104:107], a[8:11]
    v_mfma_f32_16x16x32_bf16 a[40:43], v[24:27], a[112:115], a[40:43]
    v_mfma_f32_16x16x32_bf16 a[72:75], v[24:27], a[120:123], a[72:75]
    s_add_u32 s54, s33, 10880
    s_add_u32 m0, s34, 1088
    s_nop 0
    buffer_load_dwordx4 v6, s[8:11], s54 offen lds
    ds_read_b64_tr_b16 v[44:45], v8 offset:800
    ds_read_b64_tr_b16 v[46:47], v8 offset:1840
    v_mfma_f32_16x16x32_bf16 a[12:15], v[28:31], a[104:107], a[12:15]
    v_mfma_f32_16x16x32_bf16 a[44:47], v[28:31], a[112:115], a[44:47]
    v_mfma_f32_16x16x32_bf16 a[76:79], v[28:31], a[120:123], a[76:79]
    s_add_u32 s54, s33, 21120
    s_add_u32 m0, s34, 2176
    s_nop 0
    buffer_load_dwordx4 v6, s[8:11], s54 offen lds
    ds_read_b64_tr_b16 v[16:17], v9 offset:0
    ds_read_b64_tr_b16 v[18:19], v9 offset:1040
    s_waitcnt lgkmcnt(8)
    v_mfma_f32_16x16x32_bf16 a[16:19], v[32:35], a[104:107], a[16:19]
    v_mfma_f32_16x16x32_bf16 a[48:51], v[32:35], a[112:115], a[48:51]
    v_mfma_f32_16x16x32_bf16 a[80:83], v[32:35], a[120:123], a[80:83]
    s_add_u32 s54, s33, 31360
    s_add_u32 m0, s34, 3264
    s_nop 0
    buffer_load_dwordx4 v6, s[8:11], s54 offen lds
    ds_read_b64_tr_b16 v[20:21], v9 offset:32
    ds_read_b64_tr_b16 v[22:23], v9 offset:1072
    s_waitcnt lgkmcnt(8)
    v_mfma_f32_16x16x32_bf16 a[20:23], v[36:39], a[104:107], a[20:23]
    v_mfma_f32_16x16x32_bf16 a[52:55], v[36:39], a[112:115], a[52:55]
    v_mfma_f32_16x16x32_bf16 a[84:87], v[36:39], a[120:123], a[84:87]
    s_add_u32 s54, s33, 41600
    s_add_u32 m0, s34, 4352
    s_nop 0
    buffer_load_dwordx4 v6, s[8:11], s54 offen lds
    v_add_u32 v8, 59392, v7
    v_add_u32 v9, s35, v8
    ds_read_b64_tr_b16 v[24:25], v8 offset:0
    ds_read_b64_tr_b16 v[26:27], v8 offset:1040
    s_waitcnt lgkmcnt(8)
    v_mfma_f32_16x16x32_bf16 a[24:27], v[40:43], a[104:107], a[24:27]
    v_mfma_f32_16x16x32_bf16 a[56:59], v[40:43], a[112:115], a[56:59]
    v_mfma_f32_16x16x32_bf16 a[88:91], v[40:43], a[120:123], a[88:91]
    s_add_u32 s54, s33, 51840
    s_add_u32 m0, s34, 5440
    s_nop 0
    buffer_load_dwordx4 v6, s[8:11], s54 offen lds
    ds_read_b64_tr_b16 v[28:29], v8 offset:32
    ds_read_b64_tr_b16 v[30:31], v8 offset:1072
    s_waitcnt lgkmcnt(8)
    v_mfma_f32_16x16x32_bf16 a[28:31], v[44:47], a[104:107], a[28:31]
    v_mfma_f32_16x16x32_bf16 a[60:63], v[44:47], a[112:115], a[60:63]
    v_mfma_f32_16x16x32_bf16 a[92:95], v[44:47], a[120:123], a[92:95]
    s_mov_b32 s55, 3145728
    s_add_u32 m0, s31, 42752
    s_nop 0
    buffer_load_dwordx4 v5, s[12:15], s55 offen lds
    ds_read_b64_tr_b16 v[32:33], v8 offset:256
    ds_read_b64_tr_b16 v[34:35], v8 offset:1296
    s_waitcnt lgkmcnt(8)
    v_mfma_f32_16x16x32_bf16 a[96:99], v[16:19], a[128:131], a[96:99]
    s_mov_b32 s55, 3178496
    s_add_u32 m0, s31, 43792
    s_nop 0
    buffer_load_dwordx4 v5, s[12:15], s55 offen lds
    ds_read_b64_tr_b16 v[36:37], v8 offset:288
    ds_read_b64_tr_b16 v[38:39], v8 offset:1328
    s_waitcnt lgkmcnt(8)
    v_mfma_f32_16x16x32_bf16 a[100:103], v[20:23], a[128:131], a[100:103]
    s_waitcnt vmcnt(10)
    s_barrier
    ds_read_b64_tr_b16 v[40:41], v8 offset:512
    ds_read_b64_tr_b16 v[42:43], v8 offset:1552
    s_waitcnt lgkmcnt(8)
    v_mfma_f32_16x16x32_bf16 a[0:3], v[24:27], a[108:111], a[0:3]
    v_mfma_f32_16x16x32_bf16 a[32:35], v[24:27], a[116:119], a[32:35]
    v_mfma_f32_16x16x32_bf16 a[64:67], v[24:27], a[124:127], a[64:67]
    s_mov_b32 s55, 3407872
    s_add_u32 m0, s31, 51072
    s_nop 0
    buffer_load_dwordx4 v5, s[12:15], s55 offen lds
    ds_read_b64_tr_b16 v[44:45], v8 offset:544
    ds_read_b64_tr_b16 v[46:47], v8 offset:1584
    s_waitcnt lgkmcnt(8)
    v_mfma_f32_16x16x32_bf16 a[4:7], v[28:31], a[108:111], a[4:7]
    v_mfma_f32_16x16x32_bf16 a[36:39], v[28:31], a[116:119], a[36:39]
    v_mfma_f32_16x16x32_bf16 a[68:71], v[28:31], a[124:127], a[68:71]
    s_mov_b32 s55, 3440640
    s_add_u32 m0, s31, 52112
    s_nop 0
    buffer_load_dwordx4 v5, s[12:15], s55 offen lds
    ds_read_b64_tr_b16 v[16:17], v8 offset:768
    ds_read_b64_tr_b16 v[18:19], v8 offset:1808
    s_waitcnt lgkmcnt(8)
    v_mfma_f32_16x16x32_bf16 a[8:11], v[32:35], a[108:111], a[8:11]
    v_mfma_f32_16x16x32_bf16 a[40:43], v[32:35], a[116:119], a[40:43]
    v_mfma_f32_16x16x32_bf16 a[72:75], v[32:35], a[124:127], a[72:75]
    ds_read_b64_tr_b16 v[20:21], v8 offset:800
    ds_read_b64_tr_b16 v[22:23], v8 offset:1840
    s_waitcnt lgkmcnt(8)
    v_mfma_f32_16x16x32_bf16 a[12:15], v[36:39], a[108:111], a[12:15]
    v_mfma_f32_16x16x32_bf16 a[44:47], v[36:39], a[116:119], a[44:47]
    v_mfma_f32_16x16x32_bf16 a[76:79], v[36:39], a[124:127], a[76:79]
    ds_read_b64_tr_b16 v[24:25], v9 offset:0
    ds_read_b64_tr_b16 v[26:27], v9 offset:1040
    s_waitcnt lgkmcnt(8)
    v_mfma_f32_16x16x32_bf16 a[16:19], v[40:43], a[108:111], a[16:19]
    v_mfma_f32_16x16x32_bf16 a[48:51], v[40:43], a[116:119], a[48:51]
    v_mfma_f32_16x16x32_bf16 a[80:83], v[40:43], a[124:127], a[80:83]
    ds_read_b64_tr_b16 v[28:29], v9 offset:32
    ds_read_b64_tr_b16 v[30:31], v9 offset:1072
    s_waitcnt lgkmcnt(8)
    v_mfma_f32_16x16x32_bf16 a[20:23], v[44:47], a[108:111], a[20:23]
    v_mfma_f32_16x16x32_bf16 a[52:55], v[44:47], a[116:119], a[52:55]
    v_mfma_f32_16x16x32_bf16 a[84:87], v[44:47], a[124:127], a[84:87]
    v_add_u32 v8, 26112, v7
    v_add_u32 v9, s35, v8
    ds_read_b64_tr_b16 v[32:33], v8 offset:0
    ds_read_b64_tr_b16 v[34:35], v8 offset:1040
    s_waitcnt lgkmcnt(8)
    v_mfma_f32_16x16x32_bf16 a[24:27], v[16:19], a[108:111], a[24:27]
    v_mfma_f32_16x16x32_bf16 a[56:59], v[16:19], a[116:119], a[56:59]
    v_mfma_f32_16x16x32_bf16 a[88:91], v[16:19], a[124:127], a[88:91]
    ds_read_b64_tr_b16 v[36:37], v8 offset:32
    ds_read_b64_tr_b16 v[38:39], v8 offset:1072
    s_waitcnt vmcnt(4)
    ds_read_b128 a[136:139], v10 offset:0
    ds_read_b128 a[140:143], v10 offset:64
    ds_read_b128 a[144:147], v10 offset:2176
    ds_read_b128 a[148:151], v10 offset:2240
    ds_read_b128 a[152:155], v10 offset:4352
    ds_read_b128 a[156:159], v10 offset:4416
    s_waitcnt lgkmcnt(14)
    v_mfma_f32_16x16x32_bf16 a[28:31], v[20:23], a[108:111], a[28:31]
    v_mfma_f32_16x16x32_bf16 a[60:63], v[20:23], a[116:119], a[60:63]
    v_mfma_f32_16x16x32_bf16 a[92:95], v[20:23], a[124:127], a[92:95]
    ds_read_b64_tr_b16 v[40:41], v8 offset:256
    ds_read_b64_tr_b16 v[42:43], v8 offset:1296
    s_waitcnt lgkmcnt(14)
    v_mfma_f32_16x16x32_bf16 a[96:99], v[24:27], a[132:135], a[96:99]
    ds_read_b64_tr_b16 v[44:45], v8 offset:288
    ds_read_b64_tr_b16 v[46:47], v8 offset:1328
    s_waitcnt lgkmcnt(14)
    v_mfma_f32_16x16x32_bf16 a[100:103], v[28:31], a[132:135], a[100:103]
    s_waitcnt lgkmcnt(0)
    s_barrier
    ds_read_b128 a[160:163], v11 offset:2176
    ds_read_b128 a[164:167], v11 offset:2240
    ds_read_b64_tr_b16 v[16:17], v8 offset:512
    ds_read_b64_tr_b16 v[18:19], v8 offset:1552
    v_mfma_f32_16x16x32_bf16 a[0:3], v[32:35], a[136:139], a[0:3]
    v_mfma_f32_16x16x32_bf16 a[32:35], v[32:35], a[144:147], a[32:35]
    v_mfma_f32_16x16x32_bf16 a[64:67], v[32:35], a[152:155], a[64:67]
    s_cmp_lg_u32 s28, 3
    s_cbranch_scc1 L_x12_6
    s_mov_b32 s54, 246528
    s_mov_b32 m0, 67712
    s_nop 0
    buffer_load_dwordx4 v6, s[8:11], s54 offen lds
    s_mov_b32 s54, 256768
    s_mov_b32 m0, 68800
    s_nop 0
    buffer_load_dwordx4 v6, s[8:11], s54 offen lds
L_x12_6:
    ds_read_b64_tr_b16 v[20:21], v8 offset:544
    ds_read_b64_tr_b16 v[22:23], v8 offset:1584
    v_mfma_f32_16x16x32_bf16 a[4:7], v[36:39], a[136:139], a[4:7]
    v_mfma_f32_16x16x32_bf16 a[36:39], v[36:39], a[144:147], a[36:39]
    v_mfma_f32_16x16x32_bf16 a[68:71], v[36:39], a[152:155], a[68:71]
    s_add_u32 s54, s33, 768
    s_add_u32 m0, s34, 0
    s_nop 0
    buffer_load_dwordx4 v6, s[8:11], s54 offen lds
    ds_read_b64_tr_b16 v[24:25], v8 offset:768
    ds_read_b64_tr_b16 v[26:27], v8 offset:1808
    v_mfma_f32_16x16x32_bf16 a[8:11], v[40:43], a[136:139], a[8:11]
    v_mfma_f32_16x16x32_bf16 a[40:43], v[40:43], a[144:147], a[40:43]
    v_mfma_f32_16x16x32_bf16 a[72:75], v[40:43], a[152:155], a[72:75]
    s_add_u32 s54, s33, 11008
    s_add_u32 m0, s34, 1088
    s_nop 0
    buffer_load_dwordx4 v6, s[8:11], s54 offen lds
    ds_read_b64_tr_b16 v[28:29], v8 offset:800
    ds_read_b64_tr_b16 v[30:31], v8 offset:1840
    v_mfma_f32_16x16x32_bf16 a[12:15], v[44:47], a[136:139], a[12:15]
    v_mfma_f32_16x16x32_bf16 a[44:47], v[44:47], a[144:147], a[44:47]
    v_mfma_f32_16x16x32_bf16 a[76:79], v[44:47], a[152:155], a[76:79]
    s_add_u32 s54, s33, 21248
    s_add_u32 m0, s34, 2176
    s_nop 0
    buffer_load_dwordx4 v6, s[8:11], s54 offen lds
    ds_read_b64_tr_b16 v[32:33], v9 offset:0
    ds_read_b64_tr_b16 v[34:35], v9 offset:1040
    s_waitcnt lgkmcnt(8)
    v_mfma_f32_16x16x32_bf16 a[16:19], v[16:19], a[136:139], a[16:19]
    v_mfma_f32_16x16x32_bf16 a[48:51], v[16:19], a[144:147], a[48:51]
    v_mfma_f32_16x16x32_bf16 a[80:83], v[16:19], a[152:155], a[80:83]
    s_add_u32 s54, s33, 31488
    s_add_u32 m0, s34, 3264
    s_nop 0
    buffer_load_dwordx4 v6, s[8:11], s54 offen lds
    ds_read_b64_tr_b16 v[36:37], v9 offset:32
    ds_read_b64_tr_b16 v[38:39], v9 offset:1072
    s_waitcnt lgkmcnt(8)
    v_mfma_f32_16x16x32_bf16 a[20:23], v[20:23], a[136:139], a[20:23]
    v_mfma_f32_16x16x32_bf16 a[52:55], v[20:23], a[144:147], a[52:55]
    v_mfma_f32_16x16x32_bf16 a[84:87], v[20:23], a[152:155], a[84:87]
    s_add_u32 s54, s33, 41728
    s_add_u32 m0, s34, 4352
    s_nop 0
    buffer_load_dwordx4 v6, s[8:11], s54 offen lds
    v_add_u32 v8, 34432, v7
    v_add_u32 v9, s35, v8
    ds_read_b64_tr_b16 v[40:41], v8 offset:0
    ds_read_b64_tr_b16 v[42:43], v8 offset:1040
    s_waitcnt lgkmcnt(8)
    v_mfma_f32_16x16x32_bf16 a[24:27], v[24:27], a[136:139], a[24:27]
    v_mfma_f32_16x16x32_bf16 a[56:59], v[24:27], a[144:147], a[56:59]
    v_mfma_f32_16x16x32_bf16 a[88:91], v[24:27], a[152:155], a[88:91]
    s_add_u32 s54, s33, 51968
    s_add_u32 m0, s34, 5440
    s_nop 0
    buffer_load_dwordx4 v6, s[8:11], s54 offen lds
    ds_read_b64_tr_b16 v[44:45], v8 offset:32
    ds_read_b64_tr_b16 v[46:47], v8 offset:1072
    s_waitcnt lgkmcnt(8)
    v_mfma_f32_16x16x32_bf16 a[28:31], v[28:31], a[136:139], a[28:31]
    v_mfma_f32_16x16x32_bf16 a[60:63], v[28:31], a[144:147], a[60:63]
    v_mfma_f32_16x16x32_bf16 a[92:95], v[28:31], a[152:155], a[92:95]
    s_mov_b32 s55, 3670016
    s_add_u32 m0, s31, 59392
    s_nop 0
    buffer_load_dwordx4 v5, s[12:15], s55 offen lds
    ds_read_b64_tr_b16 v[16:17], v8 offset:256
    ds_read_b64_tr_b16 v[18:19], v8 offset:1296
    s_waitcnt lgkmcnt(8)
    v_mfma_f32_16x16x32_bf16 a[96:99], v[32:35], a[160:163], a[96:99]
    s_mov_b32 s55, 3702784
    s_add_u32 m0, s31, 60432
    s_nop 0
    buffer_load_dwordx4 v5, s[12:15], s55 offen lds
    ds_read_b64_tr_b16 v[20:21], v8 offset:288
    ds_read_b64_tr_b16 v[22:23], v8 offset:1328
    s_waitcnt lgkmcnt(8)
    v_mfma_f32_16x16x32_bf16 a[100:103], v[36:39], a[160:163], a[100:103]
    s_waitcnt vmcnt(10)
    s_barrier
    ds_read_b64_tr_b16 v[24:25], v8 offset:512
    ds_read_b64_tr_b16 v[26:27], v8 offset:1552
    s_waitcnt lgkmcnt(8)
    v_mfma_f32_16x16x32_bf16 a[0:3], v[40:43], a[140:143], a[0:3]
    v_mfma_f32_16x16x32_bf16 a[32:35], v[40:43], a[148:151], a[32:35]
    v_mfma_f32_16x16x32_bf16 a[64:67], v[40:43], a[156:159], a[64:67]
    s_mov_b32 s55, 3932160
    s_add_u32 m0, s31, 26112
    s_nop 0
    buffer_load_dwordx4 v5, s[12:15], s55 offen lds
    ds_read_b64_tr_b16 v[28:29], v8 offset:544
    ds_read_b64_tr_b16 v[30:31], v8 offset:1584
    s_waitcnt lgkmcnt(8)
    v_mfma_f32_16x16x32_bf16 a[4:7], v[44:47], a[140:143], a[4:7]
    v_mfma_f32_16x16x32_bf16 a[36:39], v[44:47], a[148:151], a[36:39]
    v_mfma_f32_16x16x32_bf16 a[68:71], v[44:47], a[156:159], a[68:71]
    s_mov_b32 s55, 3964928
    s_add_u32 m0, s31, 27152
    s_nop 0
    buffer_load_dwordx4 v5, s[12:15], s55 offen lds
    ds_read_b64_tr_b16 v[32:33], v8 offset:768
    ds_read_b64_tr_b16 v[34:35], v8 offset:1808
    s_waitcnt lgkmcnt(8)
    v_mfma_f32_16x16x32_bf16 a[8:11], v[16:19], a[140:143], a[8:11]
    v_mfma_f32_16x16x32_bf16 a[40:43], v[16:19], a[148:151], a[40:43]
    v_mfma_f32_16x16x32_bf16 a[72:75], v[16:19], a[156:159], a[72:75]
    ds_read_b64_tr_b16 v[36:37], v8 offset:800
    ds_read_b64_tr_b16 v[38:39], v8 offset:1840
    s_waitcnt lgkmcnt(8)
    v_mfma_f32_16x16x32_bf16 a[12:15], v[20:23], a[140:143], a[12:15]
    v_mfma_f32_16x16x32_bf16 a[44:47], v[20:23], a[148:151], a[44:47]
    v_mfma_f32_16x16x32_bf16 a[76:79], v[20:23], a[156:159], a[76:79]
    ds_read_b64_tr_b16 v[40:41], v9 offset:0
    ds_read_b64_tr_b16 v[42:43], v9 offset:1040
    s_waitcnt lgkmcnt(8)
    v_mfma_f32_16x16x32_bf16 a[16:19], v[24:27], a[140:143], a[16:19]
    v_mfma_f32_16x16x32_bf16 a[48:51], v[24:27], a[148:151], a[48:51]
    v_mfma_f32_16x16x32_bf16 a[80:83], v[24:27], a[156:159], a[80:83]
    ds_read_b64_tr_b16 v[44:45], v9 offset:32
    ds_read_b64_tr_b16 v[46:47], v9 offset:1072
    s_waitcnt lgkmcnt(8)
    v_mfma_f32_16x16x32_bf16 a[20:23], v[28:31], a[140:143], a[20:23]
    v_mfma_f32_16x16x32_bf16 a[52:55], v[28:31], a[148:151], a[52:55]
    v_mfma_f32_16x16x32_bf16 a[84:87], v[28:31], a[156:159], a[84:87]
    v_add_u32 v8, 42752, v7
    v_add_u32 v9, s35, v8
    ds_read_b64_tr_b16 v[16:17], v8 offset:0
    ds_read_b64_tr_b16 v[18:19], v8 offset:1040
    s_waitcnt lgkmcnt(8)
    v_mfma_f32_16x16x32_bf16 a[24:27], v[32:35], a[140:143], a[24:27]
    v_mfma_f32_16x16x32_bf16 a[56:59], v[32:35], a[148:151], a[56:59]
    v_mfma_f32_16x16x32_bf16 a[88:91], v[32:35], a[156:159], a[88:91]
    ds_read_b64_tr_b16 v[20:21], v8 offset:32
    ds_read_b64_tr_b16 v[22:23], v8 offset:1072
    s_waitcnt vmcnt(4)
    ds_read_b128 a[104:107], v10 offset:0
    ds_read_b128 a[108:111], v10 offset:64
    ds_read_b128 a[112:115], v10 offset:2176
    ds_read_b128 a[116:119], v10 offset:2240
    ds_read_b128 a[120:123], v10 offset:4352
    ds_read_b128 a[124:127], v10 offset:4416
    s_waitcnt lgkmcnt(14)
    v_mfma_f32_16x16x32_bf16 a[28:31], v[36:39], a[140:143], a[28:31]
    v_mfma_f32_16x16x32_bf16 a[60:63], v[36:39], a[148:151], a[60:63]
    v_mfma_f32_16x16x32_bf16 a[92:95], v[36:39], a[156:159], a[92:95]
    ds_read_b64_tr_b16 v[24:25], v8 offset:256
    ds_read_b64_tr_b16 v[26:27], v8 offset:1296
    s_waitcnt lgkmcnt(14)
    v_mfma_f32_16x16x32_bf16 a[96:99], v[40:43], a[164:167], a[96:99]
    ds_read_b64_tr_b16 v[28:29], v8 offset:288
    ds_read_b64_tr_b16 v[30:31], v8 offset:1328
    s_waitcnt lgkmcnt(14)
    v_mfma_f32_16x16x32_bf16 a[100:103], v[44:47], a[164:167], a[100:103]
    s_waitcnt lgkmcnt(0)
    s_barrier
    ds_read_b128 a[128:131], v11 offset:0
    ds_read_b128 a[132:135], v11 offset:64
    ds_read_b64_tr_b16 v[32:33], v8 offset:512
    ds_read_b64_tr_b16 v[34:35], v8 offset:1552
    v_mfma_f32_16x16x32_bf16 a[0:3], v[16:19], a[104:107], a[0:3]
    v_mfma_f32_16x16x32_bf16 a[32:35], v[16:19], a[112:115], a[32:35]
    v_mfma_f32_16x16x32_bf16 a[64:67], v[16:19], a[120:123], a[64:67]
    s_cmp_lg_u32 s28, 3
    s_cbranch_scc1 L_x12_7
    s_mov_b32 s54, 246656
    s_mov_b32 m0, 69888
    s_nop 0
    buffer_load_dwordx4 v6, s[8:11], s54 offen lds
    s_mov_b32 s54, 256896
    s_mov_b32 m0, 70976
    s_nop 0
    buffer_load_dwordx4 v6, s[8:11], s54 offen lds
L_x12_7:
    ds_read_b64_tr_b16 v[36:37], v8 offset:544
    ds_read_b64_tr_b16 v[38:39], v8 offset:1584
    v_mfma_f32_16x16x32_bf16 a[4:7], v[20:23], a[104:107], a[4:7]
    v_mfma_f32_16x16x32_bf16 a[36:39], v[20:23], a[112:115], a[36:39]
    v_mfma_f32_16x16x32_bf16 a[68:71], v[20:23], a[120:123], a[68:71]
    s_add_u32 s54, s33, 896
    s_add_u32 m0, s34, 0
    s_nop 0
    buffer_load_dwordx4 v6, s[8:11], s54 offen lds
    ds_read_b64_tr_b16 v[40:41], v8 offset:768
    ds_read_b64_tr_b16 v[42:43], v8 offset:1808
    v_mfma_f32_16x16x32_bf16 a[8:11], v[24:27], a[104:107], a[8:11]
    v_mfma_f32_16x16x32_bf16 a[40:43], v[24:27], a[112:115], a[40:43]
    v_mfma_f32_16x16x32_bf16 a[72:75], v[24:27], a[120:123], a[72:75]
    s_add_u32 s54, s33, 11136
    s_add_u32 m0, s34, 1088
    s_nop 0
    buffer_load_dwordx4 v6, s[8:11], s54 offen lds
    ds_read_b64_tr_b16 v[44:45], v8 offset:800
    ds_read_b64_tr_b16 v[46:47], v8 offset:1840
    v_mfma_f32_16x16x32_bf16 a[12:15], v[28:31], a[104:107], a[12:15]
    v_mfma_f32_16x16x32_bf16 a[44:47], v[28:31], a[112:115], a[44:47]
    v_mfma_f32_16x16x32_bf16 a[76:79], v[28:31], a[120:123], a[76:79]
    s_add_u32 s54, s33, 21376
    s_add_u32 m0, s34, 2176
    s_nop 0
    buffer_load_dwordx4 v6, s[8:11], s54 offen lds
    ds_read_b64_tr_b16 v[16:17], v9 offset:0
    ds_read_b64_tr_b16 v[18:19], v9 offset:1040
    s_waitcnt lgkmcnt(8)
    v_mfma_f32_16x16x32_bf16 a[16:19], v[32:35], a[104:107], a[16:19]
    v_mfma_f32_16x16x32_bf16 a[48:51], v[32:35], a[112:115], a[48:51]
    v_mfma_f32_16x16x32_bf16 a[80:83], v[32:35], a[120:123], a[80:83]
    s_add_u32 s54, s33, 31616
    s_add_u32 m0, s34, 3264
    s_nop 0
    buffer_load_dwordx4 v6, s[8:11], s54 offen lds
    ds_read_b64_tr_b16 v[20:21], v9 offset:32
    ds_read_b64_tr_b16 v[22:23], v9 offset:1072
    s_waitcnt lgkmcnt(8)
    v_mfma_f32_16x16x32_bf16 a[20:23], v[36:39], a[104:107], a[20:23]
    v_mfma_f32_16x16x32_bf16 a[52:55], v[36:39], a[112:115], a[52:55]
    v_mfma_f32_16x16x32_bf16 a[84:87], v[36:39], a[120:123], a[84:87]
    s_add_u32 s54, s33, 41856
    s_add_u32 m0, s34, 4352
    s_nop 0
    buffer_load_dwordx4 v6, s[8:11], s54 offen lds
    v_add_u32 v8, 51072, v7
    v_add_u32 v9, s35, v8
    ds_read_b64_tr_b16 v[24:25], v8 offset:0
    ds_read_b64_tr_b16 v[26:27], v8 offset:1040
    s_waitcnt lgkmcnt(8)
    v_mfma_f32_16x16x32_bf16 a[24:27], v[40:43], a[104:107], a[24:27]
    v_mfma_f32_16x16x32_bf16 a[56:59], v[40:43], a[112:115], a[56:59]
    v_mfma_f32_16x16x32_bf16 a[88:91], v[40:43], a[120:123], a[88:91]
    s_add_u32 s54, s33, 52096
    s_add_u32 m0, s34, 5440
    s_nop 0
    buffer_load_dwordx4 v6, s[8:11], s54 offen lds
    ds_read_b64_tr_b16 v[28:29], v8 offset:32
    ds_read_b64_tr_b16 v[30:31], v8 offset:1072
    s_waitcnt lgkmcnt(8)
    v_mfma_f32_16x16x32_bf16 a[28:31], v[44:47], a[104:107], a[28:31]
    v_mfma_f32_16x16x32_bf16 a[60:63], v[44:47], a[112:115], a[60:63]
    v_mfma_f32_16x16x32_bf16 a[92:95], v[44:47], a[120:123], a[92:95]
    s_mov_b32 s55, 4194304
    s_add_u32 m0, s31, 34432
    s_nop 0
    buffer_load_dwordx4 v5, s[12:15], s55 offen lds
    ds_read_b64_tr_b16 v[32:33], v8 offset:256
    ds_read_b64_tr_b16 v[34:35], v8 offset:1296
    s_waitcnt lgkmcnt(8)
    v_mfma_f32_16x16x32_bf16 a[96:99], v[16:19], a[128:131], a[96:99]
    s_mov_b32 s55, 4227072
    s_add_u32 m0, s31, 35472
    s_nop 0
    buffer_load_dwordx4 v5, s[12:15], s55 offen lds
    ds_read_b64_tr_b16 v[36:37], v8 offset:288
    ds_read_b64_tr_b16 v[38:39], v8 offset:1328
    s_waitcnt lgkmcnt(8)
    v_mfma_f32_16x16x32_bf16 a[100:103], v[20:23], a[128:131], a[100:103]
    s_waitcnt vmcnt(10)
    s_barrier
    ds_read_b64_tr_b16 v[40:41], v8 offset:512
    ds_read_b64_tr_b16 v[42:43], v8 offset:1552
    s_waitcnt lgkmcnt(8)
    v_mfma_f32_16x16x32_bf16 a[0:3], v[24:27], a[108:111], a[0:3]
    v_mfma_f32_16x16x32_bf16 a[32:35], v[24:27], a[116:119], a[32:35]
    v_mfma_f32_16x16x32_bf16 a[64:67], v[24:27], a[124:127], a[64:67]
    s_mov_b32 s55, 4456448
    s_add_u32 m0, s31, 42752
    s_nop 0
    buffer_load_dwordx4 v5, s[12:15], s55 offen lds
    ds_read_b64_tr_b16 v[44:45], v8 offset:544
    ds_read_b64_tr_b16 v[46:47], v8 offset:1584
    s_waitcnt lgkmcnt(8)
    v_mfma_f32_16x16x32_bf16 a[4:7], v[28:31], a[108:111], a[4:7]
    v_mfma_f32_16x16x32_bf16 a[36:39], v[28:31], a[116:119], a[36:39]
    v_mfma_f32_16x16x32_bf16 a[68:71], v[28:31], a[124:127], a[68:71]
    s_mov_b32 s55, 4489216
    s_add_u32 m0, s31, 43792
    s_nop 0
    buffer_load_dwordx4 v5, s[12:15], s55 offen lds
    ds_read_b64_tr_b16 v[16:17], v8 offset:768
    ds_read_b64_tr_b16 v[18:19], v8 offset:1808
    s_waitcnt lgkmcnt(8)
    v_mfma_f32_16x16x32_bf16 a[8:11], v[32:35], a[108:111], a[8:11]
    v_mfma_f32_16x16x32_bf16 a[40:43], v[32:35], a[116:119], a[40:43]
    v_mfma_f32_16x16x32_bf16 a[72:75], v[32:35], a[124:127], a[72:75]
    ds_read_b64_tr_b16 v[20:21], v8 offset:800
    ds_read_b64_tr_b16 v[22:23], v8 offset:1840
    s_waitcnt lgkmcnt(8)
    v_mfma_f32_16x16x32_bf16 a[12:15], v[36:39], a[108:111], a[12:15]
    v_mfma_f32_16x16x32_bf16 a[44:47], v[36:39], a[116:119], a[44:47]
    v_mfma_f32_16x16x32_bf16 a[76:79], v[36:39], a[124:127], a[76:79]
    ds_read_b64_tr_b16 v[24:25], v9 offset:0
    ds_read_b64_tr_b16 v[26:27], v9 offset:1040
    s_waitcnt lgkmcnt(8)
    v_mfma_f32_16x16x32_bf16 a[16:19], v[40:43], a[108:111], a[16:19]
    v_mfma_f32_16x16x32_bf16 a[48:51], v[40:43], a[116:119], a[48:51]
    v_mfma_f32_16x16x32_bf16 a[80:83], v[40:43], a[124:127], a[80:83]
    ds_read_b64_tr_b16 v[28:29], v9 offset:32
    ds_read_b64_tr_b16 v[30:31], v9 offset:1072
    s_waitcnt lgkmcnt(8)
    v_mfma_f32_16x16x32_bf16 a[20:23], v[44:47], a[108:111], a[20:23]
    v_mfma_f32_16x16x32_bf16 a[52:55], v[44:47], a[116:119], a[52:55]
    v_mfma_f32_16x16x32_bf16 a[84:87], v[44:47], a[124:127], a[84:87]
    v_add_u32 v8, 59392, v7
    v_add_u32 v9, s35, v8
    ds_read_b64_tr_b16 v[32:33], v8 offset:0
    ds_read_b64_tr_b16 v[34:35], v8 offset:1040
    s_waitcnt lgkmcnt(8)
    v_mfma_f32_16x16x32_bf16 a[24:27], v[16:19], a[108:111], a[24:27]
    v_mfma_f32_16x16x32_bf16 a[56:59], v[16:19], a[116:119], a[56:59]
    v_mfma_f32_16x16x32_bf16 a[88:91], v[16:19], a[124:127], a[88:91]
    ds_read_b64_tr_b16 v[36:37], v8 offset:32
    ds_read_b64_tr_b16 v[38:39], v8 offset:1072
    s_waitcnt vmcnt(4)
    ds_read_b128 a[136:139], v10 offset:0
    ds_read_b128 a[140:143], v10 offset:64
    ds_read_b128 a[144:147], v10 offset:2176
    ds_read_b128 a[148:151], v10 offset:2240
    ds_read_b128 a[152:155], v10 offset:4352
    ds_read_b128 a[156:159], v10 offset:4416
    s_waitcnt lgkmcnt(14)
    v_mfma_f32_16x16x32_bf16 a[28:31], v[20:23], a[108:111], a[28:31]
    v_mfma_f32_16x16x32_bf16 a[60:63], v[20:23], a[116:119], a[60:63]
    v_mfma_f32_16x16x32_bf16 a[92:95], v[20:23], a[124:127], a[92:95]
    ds_read_b64_tr_b16 v[40:41], v8 offset:256
    ds_read_b64_tr_b16 v[42:43], v8 offset:1296
    s_waitcnt lgkmcnt(14)
    v_mfma_f32_16x16x32_bf16 a[96:99], v[24:27], a[132:135], a[96:99]
    ds_read_b64_tr_b16 v[44:45], v8 offset:288
    ds_read_b64_tr_b16 v[46:47], v8 offset:1328
    s_waitcnt lgkmcnt(14)
    v_mfma_f32_16x16x32_bf16 a[100:103], v[28:31], a[132:135], a[100:103]
    s_waitcnt lgkmcnt(0)
    s_barrier
    ds_read_b128 a[160:163], v11 offset:2176
    ds_read_b128 a[164:167], v11 offset:2240
    ds_read_b64_tr_b16 v[16:17], v8 offset:512
    ds_read_b64_tr_b16 v[18:19], v8 offset:1552
    v_mfma_f32_16x16x32_bf16 a[0:3], v[32:35], a[136:139], a[0:3]
    v_mfma_f32_16x16x32_bf16 a[32:35], v[32:35], a[144:147], a[32:35]
    v_mfma_f32_16x16x32_bf16 a[64:67], v[32:35], a[152:155], a[64:67]
    s_cmp_lg_u32 s28, 3
    s_cbranch_scc1 L_x12_8
    s_mov_b32 s54, 246784
    s_mov_b32 m0, 67712
    s_nop 0
    buffer_load_dwordx4 v6, s[8:11], s54 offen lds
    s_mov_b32 s54, 257024
    s_mov_b32 m0, 68800
    s_nop 0
    buffer_load_dwordx4 v6, s[8:11], s54 offen lds
L_x12_8:
    ds_read_b64_tr_b16 v[20:21], v8 offset:544
    ds_read_b64_tr_b16 v[22:23], v8 offset:1584
    v_mfma_f32_16x16x32_bf16 a[4:7], v[36:39], a[136:139], a[4:7]
    v_mfma_f32_16x16x32_bf16 a[36:39], v[36:39], a[144:147], a[36:39]
    v_mfma_f32_16x16x32_bf16 a[68:71], v[36:39], a[152:155], a[68:71]
    s_add_u32 s54, s33, 1024
    s_add_u32 m0, s34, 0
    s_nop 0
    buffer_load_dwordx4 v6, s[8:11], s54 offen lds
    ds_read_b64_tr_b16 v[24:25], v8 offset:768
    ds_read_b64_tr_b16 v[26:27], v8 offset:1808
    v_mfma_f32_16x16x32_bf16 a[8:11], v[40:43], a[136:139], a[8:11]
    v_mfma_f32_16x16x32_bf16 a[40:43], v[40:43], a[144:147], a[40:43]
    v_mfma_f32_16x16x32_bf16 a[72:75], v[40:43], a[152:155], a[72:75]
    s_add_u32 s54, s33, 11264
    s_add_u32 m0, s34, 1088
    s_nop 0
    buffer_load_dwordx4 v6, s[8:11], s54 offen lds
    ds_read_b64_tr_b16 v[28:29], v8 offset:800
    ds_read_b64_tr_b16 v[30:31], v8 offset:1840
    v_mfma_f32_16x16x32_bf16 a[12:15], v[44:47], a[136:139], a[12:15]
    v_mfma_f32_16x16x32_bf16 a[44:47], v[44:47], a[144:147], a[44:47]
    v_mfma_f32_16x16x32_bf16 a[76:79], v[44:47], a[152:155], a[76:79]
    s_add_u32 s54, s33, 21504
    s_add_u32 m0, s34, 2176
    s_nop 0
    buffer_load_dwordx4 v6, s[8:11], s54 offen lds
    ds_read_b64_tr_b16 v[32:33], v9 offset:0
    ds_read_b64_tr_b16 v[34:35], v9 offset:1040
    s_waitcnt lgkmcnt(8)
    v_mfma_f32_16x16x32_bf16 a[16:19], v[16:19], a[136:139], a[16:19]
    v_mfma_f32_16x16x32_bf16 a[48:51], v[16:19], a[144:147], a[48:51]
    v_mfma_f32_16x16x32_bf16 a[80:83], v[16:19], a[152:155], a[80:83]
    s_add_u32 s54, s33, 31744
    s_add_u32 m0, s34, 3264
    s_nop 0
    buffer_load_dwordx4 v6, s[8:11], s54 offen lds
    ds_read_b64_tr_b16 v[36:37], v9 offset:32
    ds_read_b64_tr_b16 v[38:39], v9 offset:1072
    s_waitcnt lgkmcnt(8)
    v_mfma_f32_16x16x32_bf16 a[20:23], v[20:23], a[136:139], a[20:23]
    v_mfma_f32_16x16x32_bf16 a[52:55], v[20:23], a[144:147], a[52:55]
    v_mfma_f32_16x16x32_bf16 a[84:87], v[20:23], a[152:155], a[84:87]
    s_add_u32 s54, s33, 41984
    s_add_u32 m0, s34, 4352
    s_nop 0
    buffer_load_dwordx4 v6, s[8:11], s54 offen lds
    v_add_u32 v8, 26112, v7
    v_add_u32 v9, s35, v8
    ds_read_b64_tr_b16 v[40:41], v8 offset:0
    ds_read_b64_tr_b16 v[42:43], v8 offset:1040
    s_waitcnt lgkmcnt(8)
    v_mfma_f32_16x16x32_bf16 a[24:27], v[24:27], a[136:139], a[24:27]
    v_mfma_f32_16x16x32_bf16 a[56:59], v[24:27], a[144:147], a[56:59]
    v_mfma_f32_16x16x32_bf16 a[88:91], v[24:27], a[152:155], a[88:91]
    s_add_u32 s54, s33, 52224
    s_add_u32 m0, s34, 5440
    s_nop 0
    buffer_load_dwordx4 v6, s[8:11], s54 offen lds
    ds_read_b64_tr_b16 v[44:45], v8 offset:32
    ds_read_b64_tr_b16 v[46:47], v8 offset:1072
    s_waitcnt lgkmcnt(8)
    v_mfma_f32_16x16x32_bf16 a[28:31], v[28:31], a[136:139], a[28:31]
    v_mfma_f32_16x16x32_bf16 a[60:63], v[28:31], a[144:147], a[60:63]
    v_mfma_f32_16x16x32_bf16 a[92:95], v[28:31], a[152:155], a[92:95]
    s_mov_b32 s55, 4718592
    s_add_u32 m0, s31, 51072
    s_nop 0
    buffer_load_dwordx4 v5, s[12:15], s55 offen lds
    ds_read_b64_tr_b16 v[16:17], v8 offset:256
    ds_read_b64_tr_b16 v[18:19], v8 offset:1296
    s_waitcnt lgkmcnt(8)
    v_mfma_f32_16x16x32_bf16 a[96:99], v[32:35], a[160:163], a[96:99]
    s_mov_b32 s55, 4751360
    s_add_u32 m0, s31, 52112
    s_nop 0
    buffer_load_dwordx4 v5, s[12:15], s55 offen lds
    ds_read_b64_tr_b16 v[20:21], v8 offset:288
    ds_read_b64_tr_b16 v[22:23], v8 offset:1328
    s_waitcnt lgkmcnt(8)
    v_mfma_f32_16x16x32_bf16 a[100:103], v[36:39], a[160:163], a[100:103]
    s_waitcnt vmcnt(10)
    s_barrier
    ds_read_b64_tr_b16 v[24:25], v8 offset:512
    ds_read_b64_tr_b16 v[26:27], v8 offset:1552
    s_waitcnt lgkmcnt(8)
    v_mfma_f32_16x16x32_bf16 a[0:3], v[40:43], a[140:143], a[0:3]
    v_mfma_f32_16x16x32_bf16 a[32:35], v[40:43], a[148:151], a[32:35]
    v_mfma_f32_16x16x32_bf16 a[64:67], v[40:43], a[156:159], a[64:67]
    s_mov_b32 s55, 4980736
    s_add_u32 m0, s31, 59392
    s_nop 0
    buffer_load_dwordx4 v5, s[12:15], s55 offen lds
    ds_read_b64_tr_b16 v[28:29], v8 offset:544
    ds_read_b64_tr_b16 v[30:31], v8 offset:1584
    s_waitcnt lgkmcnt(8)
    v_mfma_f32_16x16x32_bf16 a[4:7], v[44:47], a[140:143], a[4:7]
    v_mfma_f32_16x16x32_bf16 a[36:39], v[44:47], a[148:151], a[36:39]
    v_mfma_f32_16x16x32_bf16 a[68:71], v[44:47], a[156:159], a[68:71]
    s_mov_b32 s55, 5013504
    s_add_u32 m0, s31, 60432
    s_nop 0
    buffer_load_dwordx4 v5, s[12:15], s55 offen lds
    ds_read_b64_tr_b16 v[32:33], v8 offset:768
    ds_read_b64_tr_b16 v[34:35], v8 offset:1808
    s_waitcnt lgkmcnt(8)
    v_mfma_f32_16x16x32_bf16 a[8:11], v[16:19], a[140:143], a[8:11]
    v_mfma_f32_16x16x32_bf16 a[40:43], v[16:19], a[148:151], a[40:43]
    v_mfma_f32_16x16x32_bf16 a[72:75], v[16:19], a[156:159], a[72:75]
    ds_read_b64_tr_b16 v[36:37], v8 offset:800
    ds_read_b64_tr_b16 v[38:39], v8 offset:1840
    s_waitcnt lgkmcnt(8)
    v_mfma_f32_16x16x32_bf16 a[12:15], v[20:23], a[140:143], a[12:15]
    v_mfma_f32_16x16x32_bf16 a[44:47], v[20:23], a[148:151], a[44:47]
    v_mfma_f32_16x16x32_bf16 a[76:79], v[20:23], a[156:159], a[76:79]
    ds_read_b64_tr_b16 v[40:41], v9 offset:0
    ds_read_b64_tr_b16 v[42:43], v9 offset:1040
    s_waitcnt lgkmcnt(8)
    v_mfma_f32_16x16x32_bf16 a[16:19], v[24:27], a[140:143], a[16:19]
    v_mfma_f32_16x16x32_bf16 a[48:51], v[24:27], a[148:151], a[48:51]
    v_mfma_f32_16x16x32_bf16 a[80:83], v[24:27], a[156:159], a[80:83]
    ds_read_b64_tr_b16 v[44:45], v9 offset:32
    ds_read_b64_tr_b16 v[46:47], v9 offset:1072
    s_waitcnt lgkmcnt(8)
    v_mfma_f32_16x16x32_bf16 a[20:23], v[28:31], a[140:143], a[20:23]
    v_mfma_f32_16x16x32_bf16 a[52:55], v[28:31], a[148:151], a[52:55]
    v_mfma_f32_16x16x32_bf16 a[84:87], v[28:31], a[156:159], a[84:87]
    v_add_u32 v8, 34432, v7
    v_add_u32 v9, s35, v8
    ds_read_b64_tr_b16 v[16:17], v8 offset:0
    ds_read_b64_tr_b16 v[18:19], v8 offset:1040
    s_waitcnt lgkmcnt(8)
    v_mfma_f32_16x16x32_bf16 a[24:27], v[32:35], a[140:143], a[24:27]
    v_mfma_f32_16x16x32_bf16 a[56:59], v[32:35], a[148:151], a[56:59]
    v_mfma_f32_16x16x32_bf16 a[88:91], v[32:35], a[156:159], a[88:91]
    ds_read_b64_tr_b16 v[20:21], v8 offset:32
    ds_read_b64_tr_b16 v[22:23], v8 offset:1072
    s_waitcnt vmcnt(4)
    ds_read_b128 a[104:107], v10 offset:0
    ds_read_b128 a[108:111], v10 offset:64
    ds_read_b128 a[112:115], v10 offset:2176
    ds_read_b128 a[116:119], v10 offset:2240
    ds_read_b128 a[120:123], v10 offset:4352
    ds_read_b128 a[124:127], v10 offset:4416
    s_waitcnt lgkmcnt(14)
    v_mfma_f32_16x16x32_bf16 a[28:31], v[36:39], a[140:143], a[28:31]
    v_mfma_f32_16x16x32_bf16 a[60:63], v[36:39], a[148:151], a[60:63]
    v_mfma_f32_16x16x32_bf16 a[92:95], v[36:39], a[156:159], a[92:95]
    ds_read_b64_tr_b16 v[24:25], v8 offset:256
    ds_read_b64_tr_b16 v[26:27], v8 offset:1296
    s_waitcnt lgkmcnt(14)
    v_mfma_f32_16x16x32_bf16 a[96:99], v[40:43], a[164:167], a[96:99]
    ds_read_b64_tr_b16 v[28:29], v8 offset:288
    ds_read_b64_tr_b16 v[30:31], v8 offset:1328
    s_waitcnt lgkmcnt(14)
    v_mfma_f32_16x16x32_bf16 a[100:103], v[44:47], a[164:167], a[100:103]
    s_waitcnt lgkmcnt(0)
    s_barrier
    ds_read_b128 a[128:131], v11 offset:0
    ds_read_b128 a[132:135], v11 offset:64
    ds_read_b64_tr_b16 v[32:33], v8 offset:512
    ds_read_b64_tr_b16 v[34:35], v8 offset:1552
    v_mfma_f32_16x16x32_bf16 a[0:3], v[16:19], a[104:107], a[0:3]
    v_mfma_f32_16x16x32_bf16 a[32:35], v[16:19], a[112:115], a[32:35]
    v_mfma_f32_16x16x32_bf16 a[64:67], v[16:19], a[120:123], a[64:67]
    s_cmp_lg_u32 s28, 3
    s_cbranch_scc1 L_x12_9
    s_mov_b32 s54, 246912
    s_mov_b32 m0, 69888
    s_nop 0
    buffer_load_dwordx4 v6, s[8:11], s54 offen lds
    s_mov_b32 s54, 257152
    s_mov_b32 m0, 70976
    s_nop 0
    buffer_load_dwordx4 v6, s[8:11], s54 offen lds
L_x12_9:
    ds_read_b64_tr_b16 v[36:37], v8 offset:544
    ds_read_b64_tr_b16 v[38:39], v8 offset:1584
    v_mfma_f32_16x16x32_bf16 a[4:7], v[20:23], a[104:107], a[4:7]
    v_mfma_f32_16x16x32_bf16 a[36:39], v[20:23], a[112:115], a[36:39]
    v_mfma_f32_16x16x32_bf16 a[68:71], v[20:23], a[120:123], a[68:71]
    s_add_u32 s54, s33, 1152
    s_add_u32 m0, s34, 0
    s_nop 0
    buffer_load_dwordx4 v6, s[8:11], s54 offen lds
    ds_read_b64_tr_b16 v[40:41], v8 offset:768
    ds_read_b64_tr_b16 v[42:43], v8 offset:1808
    v_mfma_f32_16x16x32_bf16 a[8:11], v[24:27], a[104:107], a[8:11]
    v_mfma_f32_16x16x32_bf16 a[40:43], v[24:27], a[112:115], a[40:43]
    v_mfma_f32_16x16x32_bf16 a[72:75], v[24:27], a[120:123], a[72:75]
    s_add_u32 s54, s33, 11392
    s_add_u32 m0, s34, 1088
    s_nop 0
    buffer_load_dwordx4 v6, s[8:11], s54 offen lds
    ds_read_b64_tr_b16 v[44:45], v8 offset:800
    ds_read_b64_tr_b16 v[46:47], v8 offset:1840
    v_mfma_f32_16x16x32_bf16 a[12:15], v[28:31], a[104:107], a[12:15]
    v_mfma_f32_16x16x32_bf16 a[44:47], v[28:31], a[112:115], a[44:47]
    v_mfma_f32_16x16x32_bf16 a[76:79], v[28:31], a[120:123], a[76:79]
    s_add_u32 s54, s33, 21632
    s_add_u32 m0, s34, 2176
    s_nop 0
    buffer_load_dwordx4 v6, s[8:11], s54 offen lds
    ds_read_b64_tr_b16 v[16:17], v9 offset:0
    ds_read_b64_tr_b16 v[18:19], v9 offset:1040
    s_waitcnt lgkmcnt(8)
    v_mfma_f32_16x16x32_bf16 a[16:19], v[32:35], a[104:107], a[16:19]
    v_mfma_f32_16x16x32_bf16 a[48:51], v[32:35], a[112:115], a[48:51]
    v_mfma_f32_16x16x32_bf16 a[80:83], v[32:35], a[120:123], a[80:83]
    s_add_u32 s54, s33, 31872
    s_add_u32 m0, s34, 3264
    s_nop 0
    buffer_load_dwordx4 v6, s[8:11], s54 offen lds
    ds_read_b64_tr_b16 v[20:21], v9 offset:32
    ds_read_b64_tr_b16 v[22:23], v9 offset:1072
    s_waitcnt lgkmcnt(8)
    v_mfma_f32_16x16x32_bf16 a[20:23], v[36:39], a[104:107], a[20:23]
    v_mfma_f32_16x16x32_bf16 a[52:55], v[36:39], a[112:115], a[52:55]
    v_mfma_f32_16x16x32_bf16 a[84:87], v[36:39], a[120:123], a[84:87]
    s_add_u32 s54, s33, 42112
    s_add_u32 m0, s34, 4352
    s_nop 0
    buffer_load_dwordx4 v6, s[8:11], s54 offen lds
    v_add_u32 v8, 42752, v7
    v_add_u32 v9, s35, v8
    ds_read_b64_tr_b16 v[24:25], v8 offset:0
    ds_read_b64_tr_b16 v[26:27], v8 offset:1040
    s_waitcnt lgkmcnt(8)
    v_mfma_f32_16x16x32_bf16 a[24:27], v[40:43], a[104:107], a[24:27]
    v_mfma_f32_16x16x32_bf16 a[56:59], v[40:43], a[112:115], a[56:59]
    v_mfma_f32_16x16x32_bf16 a[88:91], v[40:43], a[120:123], a[88:91]
    s_add_u32 s54, s33, 52352
    s_add_u32 m0, s34, 5440
    s_nop 0
    buffer_load_dwordx4 v6, s[8:11], s54 offen lds
    ds_read_b64_tr_b16 v[28:29], v8 offset:32
    ds_read_b64_tr_b16 v[30:31], v8 offset:1072
    s_waitcnt lgkmcnt(8)
    v_mfma_f32_16x16x32_bf16 a[28:31], v[44:47], a[104:107], a[28:31]
    v_mfma_f32_16x16x32_bf16 a[60:63], v[44:47], a[112:115], a[60:63]
    v_mfma_f32_16x16x32_bf16 a[92:95], v[44:47], a[120:123], a[92:95]
    ds_read_b64_tr_b16 v[32:33], v8 offset:256
    ds_read_b64_tr_b16 v[34:35], v8 offset:1296
    s_waitcnt lgkmcnt(8)
    v_mfma_f32_16x16x32_bf16 a[96:99], v[16:19], a[128:131], a[96:99]
    ds_read_b64_tr_b16 v[36:37], v8 offset:288
    ds_read_b64_tr_b16 v[38:39], v8 offset:1328
    s_waitcnt lgkmcnt(8)
    v_mfma_f32_16x16x32_bf16 a[100:103], v[20:23], a[128:131], a[100:103]
    s_waitcnt vmcnt(8)
    s_barrier
    ds_read_b64_tr_b16 v[40:41], v8 offset:512
    ds_read_b64_tr_b16 v[42:43], v8 offset:1552
    s_waitcnt lgkmcnt(8)
    v_mfma_f32_16x16x32_bf16 a[0:3], v[24:27], a[108:111], a[0:3]
    v_mfma_f32_16x16x32_bf16 a[32:35], v[24:27], a[116:119], a[32:35]
    v_mfma_f32_16x16x32_bf16 a[64:67], v[24:27], a[124:127], a[64:67]
    ds_read_b64_tr_b16 v[44:45], v8 offset:544
    ds_read_b64_tr_b16 v[46:47], v8 offset:1584
    s_waitcnt lgkmcnt(8)
    v_mfma_f32_16x16x32_bf16 a[4:7], v[28:31], a[108:111], a[4:7]
    v_mfma_f32_16x16x32_bf16 a[36:39], v[28:31], a[116:119], a[36:39]
    v_mfma_f32_16x16x32_bf16 a[68:71], v[28:31], a[124:127], a[68:71]
    ds_read_b64_tr_b16 v[16:17], v8 offset:768
    ds_read_b64_tr_b16 v[18:19], v8 offset:1808
    s_waitcnt lgkmcnt(8)
    v_mfma_f32_16x16x32_bf16 a[8:11], v[32:35], a[108:111], a[8:11]
    v_mfma_f32_16x16x32_bf16 a[40:43], v[32:35], a[116:119], a[40:43]
    v_mfma_f32_16x16x32_bf16 a[72:75], v[32:35], a[124:127], a[72:75]
    ds_read_b64_tr_b16 v[20:21], v8 offset:800
    ds_read_b64_tr_b16 v[22:23], v8 offset:1840
    s_waitcnt lgkmcnt(8)
    v_mfma_f32_16x16x32_bf16 a[12:15], v[36:39], a[108:111], a[12:15]
    v_mfma_f32_16x16x32_bf16 a[44:47], v[36:39], a[116:119], a[44:47]
    v_mfma_f32_16x16x32_bf16 a[76:79], v[36:39], a[124:127], a[76:79]
    ds_read_b64_tr_b16 v[24:25], v9 offset:0
    ds_read_b64_tr_b16 v[26:27], v9 offset:1040
    s_waitcnt lgkmcnt(8)
    v_mfma_f32_16x16x32_bf16 a[16:19], v[40:43], a[108:111], a[16:19]
    v_mfma_f32_16x16x32_bf16 a[48:51], v[40:43], a[116:119], a[48:51]
    v_mfma_f32_16x16x32_bf16 a[80:83], v[40:43], a[124:127], a[80:83]
    ds_read_b64_tr_b16 v[28:29], v9 offset:32
    ds_read_b64_tr_b16 v[30:31], v9 offset:1072
    s_waitcnt lgkmcnt(8)
    v_mfma_f32_16x16x32_bf16 a[20:23], v[44:47], a[108:111], a[20:23]
    v_mfma_f32_16x16x32_bf16 a[52:55], v[44:47], a[116:119], a[52:55]
    v_mfma_f32_16x16x32_bf16 a[84:87], v[44:47], a[124:127], a[84:87]
    v_add_u32 v8, 51072, v7
    v_add_u32 v9, s35, v8
    ds_read_b64_tr_b16 v[32:33], v8 offset:0
    ds_read_b64_tr_b16 v[34:35], v8 offset:1040
    s_waitcnt lgkmcnt(8)
    v_mfma_f32_16x16x32_bf16 a[24:27], v[16:19], a[108:111], a[24:27]
    v_mfma_f32_16x16x32_bf16 a[56:59], v[16:19], a[116:119], a[56:59]
    v_mfma_f32_16x16x32_bf16 a[88:91], v[16:19], a[124:127], a[88:91]
    ds_read_b64_tr_b16 v[36:37], v8 offset:32
    ds_read_b64_tr_b16 v[38:39], v8 offset:1072
    s_waitcnt vmcnt(0)
    ds_read_b128 a[136:139], v10 offset:0
    ds_read_b128 a[140:143], v10 offset:64
    ds_read_b128 a[144:147], v10 offset:2176
    ds_read_b128 a[148:151], v10 offset:2240
    ds_read_b128 a[152:155], v10 offset:4352
    ds_read_b128 a[156:159], v10 offset:4416
    s_waitcnt lgkmcnt(14)
    v_mfma_f32_16x16x32_bf16 a[28:31], v[20:23], a[108:111], a[28:31]
    v_mfma_f32_16x16x32_bf16 a[60:63], v[20:23], a[116:119], a[60:63]
    v_mfma_f32_16x16x32_bf16 a[92:95], v[20:23], a[124:127], a[92:95]
    ds_read_b64_tr_b16 v[40:41], v8 offset:256
    ds_read_b64_tr_b16 v[42:43], v8 offset:1296
    s_waitcnt lgkmcnt(14)
    v_mfma_f32_16x16x32_bf16 a[96:99], v[24:27], a[132:135], a[96:99]
    ds_read_b64_tr_b16 v[44:45], v8 offset:288
    ds_read_b64_tr_b16 v[46:47], v8 offset:1328
    s_waitcnt lgkmcnt(14)
    v_mfma_f32_16x16x32_bf16 a[100:103], v[28:31], a[132:135], a[100:103]
    s_waitcnt lgkmcnt(0)
    s_barrier
    ds_read_b128 a[160:163], v11 offset:2176
    ds_read_b128 a[164:167], v11 offset:2240
    ds_read_b64_tr_b16 v[16:17], v8 offset:512
    ds_read_b64_tr_b16 v[18:19], v8 offset:1552
    v_mfma_f32_16x16x32_bf16 a[0:3], v[32:35], a[136:139], a[0:3]
    v_mfma_f32_16x16x32_bf16 a[32:35], v[32:35], a[144:147], a[32:35]
    v_mfma_f32_16x16x32_bf16 a[64:67], v[32:35], a[152:155], a[64:67]
    s_mov_b32 s54, 0
    s_add_u32 m0, s32, 0
    s_nop 0
    buffer_load_dwordx4 v76, s[16:19], s54 offen nt lds
    s_add_u32 m0, m0, 32
    s_nop 0
    buffer_load_dwordx4 v76, s[16:19], s54 offen offset:1024 nt lds
    ds_read_b64_tr_b16 v[20:21], v8 offset:544
    ds_read_b64_tr_b16 v[22:23], v8 offset:1584
    v_mfma_f32_16x16x32_bf16 a[4:7], v[36:39], a[136:139], a[4:7]
    v_mfma_f32_16x16x32_bf16 a[36:39], v[36:39], a[144:147], a[36:39]
    v_mfma_f32_16x16x32_bf16 a[68:71], v[36:39], a[152:155], a[68:71]
    s_mov_b32 s54, 8192
    s_add_u32 m0, s32, 8448
    s_nop 0
    buffer_load_dwordx4 v76, s[16:19], s54 offen nt lds
    s_add_u32 m0, m0, 32
    s_nop 0
    buffer_load_dwordx4 v76, s[16:19], s54 offen offset:1024 nt lds
    ds_read_b64_tr_b16 v[24:25], v8 offset:768
    ds_read_b64_tr_b16 v[26:27], v8 offset:1808
    v_mfma_f32_16x16x32_bf16 a[8:11], v[40:43], a[136:139], a[8:11]
    v_mfma_f32_16x16x32_bf16 a[40:43], v[40:43], a[144:147], a[40:43]
    v_mfma_f32_16x16x32_bf16 a[72:75], v[40:43], a[152:155], a[72:75]
    s_mov_b32 s54, 0
    s_add_u32 m0, s32, 16896
    s_nop 0
    buffer_load_dwordx4 v76, s[20:23], s54 offen nt lds
    s_add_u32 m0, m0, 32
    s_nop 0
    buffer_load_dwordx4 v76, s[20:23], s54 offen offset:1024 nt lds
    ds_read_b64_tr_b16 v[28:29], v8 offset:800
    ds_read_b64_tr_b16 v[30:31], v8 offset:1840
    v_mfma_f32_16x16x32_bf16 a[12:15], v[44:47], a[136:139], a[12:15]
    v_mfma_f32_16x16x32_bf16 a[44:47], v[44:47], a[144:147], a[44:47]
    v_mfma_f32_16x16x32_bf16 a[76:79], v[44:47], a[152:155], a[76:79]
    ds_read_b64_tr_b16 v[32:33], v9 offset:0
    ds_read_b64_tr_b16 v[34:35], v9 offset:1040
    s_waitcnt lgkmcnt(8)
    v_mfma_f32_16x16x32_bf16 a[16:19], v[16:19], a[136:139], a[16:19]
    v_mfma_f32_16x16x32_bf16 a[48:51], v[16:19], a[144:147], a[48:51]
    v_mfma_f32_16x16x32_bf16 a[80:83], v[16:19], a[152:155], a[80:83]
    ds_read_b64_tr_b16 v[36:37], v9 offset:32
    ds_read_b64_tr_b16 v[38:39], v9 offset:1072
    s_waitcnt lgkmcnt(8)
    v_mfma_f32_16x16x32_bf16 a[20:23], v[20:23], a[136:139], a[20:23]
    v_mfma_f32_16x16x32_bf16 a[52:55], v[20:23], a[144:147], a[52:55]
    v_mfma_f32_16x16x32_bf16 a[84:87], v[20:23], a[152:155], a[84:87]
    v_add_u32 v8, 59392, v7
    v_add_u32 v9, s35, v8
    ds_read_b64_tr_b16 v[40:41], v8 offset:0
    ds_read_b64_tr_b16 v[42:43], v8 offset:1040
    s_waitcnt lgkmcnt(8)
    v_mfma_f32_16x16x32_bf16 a[24:27], v[24:27], a[136:139], a[24:27]
    v_mfma_f32_16x16x32_bf16 a[56:59], v[24:27], a[144:147], a[56:59]
    v_mfma_f32_16x16x32_bf16 a[88:91], v[24:27], a[152:155], a[88:91]
    ds_read_b64_tr_b16 v[44:45], v8 offset:32
    ds_read_b64_tr_b16 v[46:47], v8 offset:1072
    s_waitcnt lgkmcnt(8)
    v_mfma_f32_16x16x32_bf16 a[28:31], v[28:31], a[136:139], a[28:31]
    v_mfma_f32_16x16x32_bf16 a[60:63], v[28:31], a[144:147], a[60:63]
    v_mfma_f32_16x16x32_bf16 a[92:95], v[28:31], a[152:155], a[92:95]
    ds_read_b64_tr_b16 v[16:17], v8 offset:256
    ds_read_b64_tr_b16 v[18:19], v8 offset:1296
    s_waitcnt lgkmcnt(8)
    v_mfma_f32_16x16x32_bf16 a[96:99], v[32:35], a[160:163], a[96:99]
    ds_read_b64_tr_b16 v[20:21], v8 offset:288
    ds_read_b64_tr_b16 v[22:23], v8 offset:1328
    s_waitcnt lgkmcnt(8)
    v_mfma_f32_16x16x32_bf16 a[100:103], v[36:39], a[160:163], a[100:103]
    s_barrier
    ds_read_b64_tr_b16 v[24:25], v8 offset:512
    ds_read_b64_tr_b16 v[26:27], v8 offset:1552
    s_waitcnt lgkmcnt(8)
    v_mfma_f32_16x16x32_bf16 a[0:3], v[40:43], a[140:143], a[0:3]
    v_mfma_f32_16x16x32_bf16 a[32:35], v[40:43], a[148:151], a[32:35]
    v_mfma_f32_16x16x32_bf16 a[64:67], v[40:43], a[156:159], a[64:67]
    s_mov_b32 s54, 8192
    s_add_u32 m0, s32, 25344
    s_nop 0
    buffer_load_dwordx4 v76, s[20:23], s54 offen nt lds
    s_add_u32 m0, m0, 32
    s_nop 0
    buffer_load_dwordx4 v76, s[20:23], s54 offen offset:1024 nt lds
    ds_read_b64_tr_b16 v[28:29], v8 offset:544
    ds_read_b64_tr_b16 v[30:31], v8 offset:1584
    s_waitcnt lgkmcnt(8)
    v_mfma_f32_16x16x32_bf16 a[4:7], v[44:47], a[140:143], a[4:7]
    v_mfma_f32_16x16x32_bf16 a[36:39], v[44:47], a[148:151], a[36:39]
    v_mfma_f32_16x16x32_bf16 a[68:71], v[44:47], a[156:159], a[68:71]
    s_mov_b32 s54, 16384
    s_add_u32 m0, s32, 33792
    s_nop 0
    buffer_load_dwordx4 v76, s[16:19], s54 offen nt lds
    s_add_u32 m0, m0, 32
    s_nop 0
    buffer_load_dwordx4 v76, s[16:19], s54 offen offset:1024 nt lds
    ds_read_b64_tr_b16 v[32:33], v8 offset:768
    ds_read_b64_tr_b16 v[34:35], v8 offset:1808
    s_waitcnt lgkmcnt(8)
    v_mfma_f32_16x16x32_bf16 a[8:11], v[16:19], a[140:143], a[8:11]
    v_mfma_f32_16x16x32_bf16 a[40:43], v[16:19], a[148:151], a[40:43]
    v_mfma_f32_16x16x32_bf16 a[72:75], v[16:19], a[156:159], a[72:75]
    ds_read_b64_tr_b16 v[36:37], v8 offset:800
    ds_read_b64_tr_b16 v[38:39], v8 offset:1840
    s_waitcnt lgkmcnt(8)
    v_mfma_f32_16x16x32_bf16 a[12:15], v[20:23], a[140:143], a[12:15]
    v_mfma_f32_16x16x32_bf16 a[44:47], v[20:23], a[148:151], a[44:47]
    v_mfma_f32_16x16x32_bf16 a[76:79], v[20:23], a[156:159], a[76:79]
    ds_read_b64_tr_b16 v[40:41], v9 offset:0
    ds_read_b64_tr_b16 v[42:43], v9 offset:1040
    s_waitcnt lgkmcnt(8)
    v_mfma_f32_16x16x32_bf16 a[16:19], v[24:27], a[140:143], a[16:19]
    v_mfma_f32_16x16x32_bf16 a[48:51], v[24:27], a[148:151], a[48:51]
    v_mfma_f32_16x16x32_bf16 a[80:83], v[24:27], a[156:159], a[80:83]
    ds_read_b64_tr_b16 v[44:45], v9 offset:32
    ds_read_b64_tr_b16 v[46:47], v9 offset:1072
    s_waitcnt lgkmcnt(8)
    v_mfma_f32_16x16x32_bf16 a[20:23], v[28:31], a[140:143], a[20:23]
    v_mfma_f32_16x16x32_bf16 a[52:55], v[28:31], a[148:151], a[52:55]
    v_mfma_f32_16x16x32_bf16 a[84:87], v[28:31], a[156:159], a[84:87]
    s_waitcnt lgkmcnt(6)
    v_mfma_f32_16x16x32_bf16 a[24:27], v[32:35], a[140:143], a[24:27]
    v_mfma_f32_16x16x32_bf16 a[56:59], v[32:35], a[148:151], a[56:59]
    v_mfma_f32_16x16x32_bf16 a[88:91], v[32:35], a[156:159], a[88:91]
    s_waitcnt lgkmcnt(4)
    v_mfma_f32_16x16x32_bf16 a[28:31], v[36:39], a[140:143], a[28:31]
    v_mfma_f32_16x16x32_bf16 a[60:63], v[36:39], a[148:151], a[60:63]
    v_mfma_f32_16x16x32_bf16 a[92:95], v[36:39], a[156:159], a[92:95]
    s_waitcnt lgkmcnt(2)
    v_mfma_f32_16x16x32_bf16 a[96:99], v[40:43], a[164:167], a[96:99]
    s_waitcnt lgkmcnt(0)
    v_mfma_f32_16x16x32_bf16 a[100:103], v[44:47], a[164:167], a[100:103]
    s_waitcnt lgkmcnt(0)
    s_mov_b32 s3, 0x3e0293ee
    s_nop 3
    v_accvgpr_read_b32 v16, a96
    v_accvgpr_read_b32 v17, a97
    v_accvgpr_read_b32 v18, a98
    v_accvgpr_read_b32 v19, a99
    v_accvgpr_read_b32 v20, a100
    v_accvgpr_read_b32 v21, a101
    v_accvgpr_read_b32 v22, a102
    v_accvgpr_read_b32 v23, a103
    v_mul_f32 v16, s3, v16
    v_mul_f32 v17, s3, v17
    v_mul_f32 v18, s3, v18
    v_mul_f32 v19, s3, v19
    v_mul_f32 v20, s3, v20
    v_mul_f32 v21, s3, v21
    v_mul_f32 v22, s3, v22
    v_mul_f32 v23, s3, v23
    v_cvt_pk_bf16_f32 v32, v16, v17
    v_cvt_pk_bf16_f32 v33, v18, v19
    v_cvt_pk_bf16_f32 v34, v20, v21
    v_cvt_pk_bf16_f32 v35, v22, v23
    s_nop 0
    v_permlane32_swap_b32 v32, v34
    v_permlane32_swap_b32 v33, v35
    s_nop 0
    v_permlane16_swap_b32 v32, v34
    v_permlane16_swap_b32 v33, v35
    s_lshl_b32 s4, s28, 10
    v_add_u32 v9, s4, v77
    ds_write_b128 v9, v[32:35] offset:0
    v_accvgpr_read_b32 v16, a0
    v_accvgpr_read_b32 v17, a1
    v_accvgpr_read_b32 v18, a2
    v_accvgpr_read_b32 v19, a3
    v_accvgpr_read_b32 v20, a4
    v_accvgpr_read_b32 v21, a5
    v_accvgpr_read_b32 v22, a6
    v_accvgpr_read_b32 v23, a7
    v_mul_f32 v16, s3, v16
    v_mul_f32 v17, s3, v17
    v_mul_f32 v18, s3, v18
    v_mul_f32 v19, s3, v19
    v_mul_f32 v20, s3, v20
    v_mul_f32 v21, s3, v21
    v_mul_f32 v22, s3, v22
    v_mul_f32 v23, s3, v23
    v_cvt_pk_bf16_f32 v36, v16, v17
    v_cvt_pk_bf16_f32 v37, v18, v19
    v_cvt_pk_bf16_f32 v38, v20, v21
    v_cvt_pk_bf16_f32 v39, v22, v23
    s_nop 0
    v_permlane32_swap_b32 v36, v38
    v_permlane32_swap_b32 v37, v39
    s_nop 0
    v_permlane16_swap_b32 v36, v38
    v_permlane16_swap_b32 v37, v39
    v_accvgpr_write_b32 a128, v36
    v_accvgpr_write_b32 a129, v37
    v_accvgpr_write_b32 a130, v38
    v_accvgpr_write_b32 a131, v39
    v_accvgpr_read_b32 v24, a8
    v_accvgpr_read_b32 v25, a9
    v_accvgpr_read_b32 v26, a10
    v_accvgpr_read_b32 v27, a11
    v_accvgpr_read_b32 v28, a12
    v_accvgpr_read_b32 v29, a13
    v_accvgpr_read_b32 v30, a14
    v_accvgpr_read_b32 v31, a15
    v_mul_f32 v24, s3, v24
    v_mul_f32 v25, s3, v25
    v_mul_f32 v26, s3, v26
    v_mul_f32 v27, s3, v27
    v_mul_f32 v28, s3, v28
    v_mul_f32 v29, s3, v29
    v_mul_f32 v30, s3, v30
    v_mul_f32 v31, s3, v31
    v_cvt_pk_bf16_f32 v40, v24, v25
    v_cvt_pk_bf16_f32 v41, v26, v27
    v_cvt_pk_bf16_f32 v42, v28, v29
    v_cvt_pk_bf16_f32 v43, v30, v31
    s_nop 0
    v_permlane32_swap_b32 v40, v42
    v_permlane32_swap_b32 v41, v43
    s_nop 0
    v_permlane16_swap_b32 v40, v42
    v_permlane16_swap_b32 v41, v43
    v_accvgpr_write_b32 a132, v40
    v_accvgpr_write_b32 a133, v41
    v_accvgpr_write_b32 a134, v42
    v_accvgpr_write_b32 a135, v43
    v_accvgpr_read_b32 v16, a16
    v_accvgpr_read_b32 v17, a17
    v_accvgpr_read_b32 v18, a18
    v_accvgpr_read_b32 v19, a19
    v_accvgpr_read_b32 v20, a20
    v_accvgpr_read_b32 v21, a21
    v_accvgpr_read_b32 v22, a22
    v_accvgpr_read_b32 v23, a23
    v_mul_f32 v16, s3, v16
    v_mul_f32 v17, s3, v17
    v_mul_f32 v18, s3, v18
    v_mul_f32 v19, s3, v19
    v_mul_f32 v20, s3, v20
    v_mul_f32 v21, s3, v21
    v_mul_f32 v22, s3, v22
    v_mul_f32 v23, s3, v23
    v_cvt_pk_bf16_f32 v36, v16, v17
    v_cvt_pk_bf16_f32 v37, v18, v19
    v_cvt_pk_bf16_f32 v38, v20, v21
    v_cvt_pk_bf16_f32 v39, v22, v23
    s_nop 0
    v_permlane32_swap_b32 v36, v38
    v_permlane32_swap_b32 v37, v39
    s_nop 0
    v_permlane16_swap_b32 v36, v38
    v_permlane16_swap_b32 v37, v39
    v_accvgpr_write_b32 a136, v36
    v_accvgpr_write_b32 a137, v37
    v_accvgpr_write_b32 a138, v38
    v_accvgpr_write_b32 a139, v39
    v_accvgpr_read_b32 v24, a24
    v_accvgpr_read_b32 v25, a25
    v_accvgpr_read_b32 v26, a26
    v_accvgpr_read_b32 v27, a27
    v_accvgpr_read_b32 v28, a28
    v_accvgpr_read_b32 v29, a29
    v_accvgpr_read_b32 v30, a30
    v_accvgpr_read_b32 v31, a31
    v_mul_f32 v24, s3, v24
    v_mul_f32 v25, s3, v25
    v_mul_f32 v26, s3, v26
    v_mul_f32 v27, s3, v27
    v_mul_f32 v28, s3, v28
    v_mul_f32 v29, s3, v29
    v_mul_f32 v30, s3, v30
    v_mul_f32 v31, s3, v31
    v_cvt_pk_bf16_f32 v40, v24, v25
    v_cvt_pk_bf16_f32 v41, v26, v27
    v_cvt_pk_bf16_f32 v42, v28, v29
    v_cvt_pk_bf16_f32 v43, v30, v31
    s_nop 0
    v_permlane32_swap_b32 v40, v42
    v_permlane32_swap_b32 v41, v43
    s_nop 0
    v_permlane16_swap_b32 v40, v42
    v_permlane16_swap_b32 v41, v43
    v_accvgpr_write_b32 a140, v40
    v_accvgpr_write_b32 a141, v41
    v_accvgpr_write_b32 a142, v42
    v_accvgpr_write_b32 a143, v43
    v_accvgpr_read_b32 v16, a32
    v_accvgpr_read_b32 v17, a33
    v_accvgpr_read_b32 v18, a34
    v_accvgpr_read_b32 v19, a35
    v_accvgpr_read_b32 v20, a36
    v_accvgpr_read_b32 v21, a37
    v_accvgpr_read_b32 v22, a38
    v_accvgpr_read_b32 v23, a39
    v_mul_f32 v16, s3, v16
    v_mul_f32 v17, s3, v17
    v_mul_f32 v18, s3, v18
    v_mul_f32 v19, s3, v19
    v_mul_f32 v20, s3, v20
    v_mul_f32 v21, s3, v21
    v_mul_f32 v22, s3, v22
    v_mul_f32 v23, s3, v23
    v_cvt_pk_bf16_f32 v36, v16, v17
    v_cvt_pk_bf16_f32 v37, v18, v19
    v_cvt_pk_bf16_f32 v38, v20, v21
    v_cvt_pk_bf16_f32 v39, v22, v23
    s_nop 0
    v_permlane32_swap_b32 v36, v38
    v_permlane32_swap_b32 v37, v39
    s_nop 0
    v_permlane16_swap_b32 v36, v38
    v_permlane16_swap_b32 v37, v39
    v_accvgpr_write_b32 a144, v36
    v_accvgpr_write_b32 a145, v37
    v_accvgpr_write_b32 a146, v38
    v_accvgpr_write_b32 a147, v39
    v_accvgpr_read_b32 v24, a40
    v_accvgpr_read_b32 v25, a41
    v_accvgpr_read_b32 v26, a42
    v_accvgpr_read_b32 v27, a43
    v_accvgpr_read_b32 v28, a44
    v_accvgpr_read_b32 v29, a45
    v_accvgpr_read_b32 v30, a46
    v_accvgpr_read_b32 v31, a47
    v_mul_f32 v24, s3, v24
    v_mul_f32 v25, s3, v25
    v_mul_f32 v26, s3, v26
    v_mul_f32 v27, s3, v27
    v_mul_f32 v28, s3, v28
    v_mul_f32 v29, s3, v29
    v_mul_f32 v30, s3, v30
    v_mul_f32 v31, s3, v31
    v_cvt_pk_bf16_f32 v40, v24, v25
    v_cvt_pk_bf16_f32 v41, v26, v27
    v_cvt_pk_bf16_f32 v42, v28, v29
    v_cvt_pk_bf16_f32 v43, v30, v31
    s_nop 0
    v_permlane32_swap_b32 v40, v42
    v_permlane32_swap_b32 v41, v43
    s_nop 0
    v_permlane16_swap_b32 v40, v42
    v_permlane16_swap_b32 v41, v43
    v_accvgpr_write_b32 a148, v40
    v_accvgpr_write_b32 a149, v41
    v_accvgpr_write_b32 a150, v42
    v_accvgpr_write_b32 a151, v43
    v_accvgpr_read_b32 v16, a48
    v_accvgpr_read_b32 v17, a49
    v_accvgpr_read_b32 v18, a50
    v_accvgpr_read_b32 v19, a51
    v_accvgpr_read_b32 v20, a52
    v_accvgpr_read_b32 v21, a53
    v_accvgpr_read_b32 v22, a54
    v_accvgpr_read_b32 v23, a55
    v_mul_f32 v16, s3, v16
    v_mul_f32 v17, s3, v17
    v_mul_f32 v18, s3, v18
    v_mul_f32 v19, s3, v19
    v_mul_f32 v20, s3, v20
    v_mul_f32 v21, s3, v21
    v_mul_f32 v22, s3, v22
    v_mul_f32 v23, s3, v23
    v_cvt_pk_bf16_f32 v36, v16, v17
    v_cvt_pk_bf16_f32 v37, v18, v19
    v_cvt_pk_bf16_f32 v38, v20, v21
    v_cvt_pk_bf16_f32 v39, v22, v23
    s_nop 0
    v_permlane32_swap_b32 v36, v38
    v_permlane32_swap_b32 v37, v39
    s_nop 0
    v_permlane16_swap_b32 v36, v38
    v_permlane16_swap_b32 v37, v39
    v_accvgpr_write_b32 a152, v36
    v_accvgpr_write_b32 a153, v37
    v_accvgpr_write_b32 a154, v38
    v_accvgpr_write_b32 a155, v39
    v_accvgpr_read_b32 v24, a56
    v_accvgpr_read_b32 v25, a57
    v_accvgpr_read_b32 v26, a58
    v_accvgpr_read_b32 v27, a59
    v_accvgpr_read_b32 v28, a60
    v_accvgpr_read_b32 v29, a61
    v_accvgpr_read_b32 v30, a62
    v_accvgpr_read_b32 v31, a63
    v_mul_f32 v24, s3, v24
    v_mul_f32 v25, s3, v25
    v_mul_f32 v26, s3, v26
    v_mul_f32 v27, s3, v27
    v_mul_f32 v28, s3, v28
    v_mul_f32 v29, s3, v29
    v_mul_f32 v30, s3, v30
    v_mul_f32 v31, s3, v31
    v_cvt_pk_bf16_f32 v40, v24, v25
    v_cvt_pk_bf16_f32 v41, v26, v27
    v_cvt_pk_bf16_f32 v42, v28, v29
    v_cvt_pk_bf16_f32 v43, v30, v31
    s_nop 0
    v_permlane32_swap_b32 v40, v42
    v_permlane32_swap_b32 v41, v43
    s_nop 0
    v_permlane16_swap_b32 v40, v42
    v_permlane16_swap_b32 v41, v43
    v_accvgpr_write_b32 a156, v40
    v_accvgpr_write_b32 a157, v41
    v_accvgpr_write_b32 a158, v42
    v_accvgpr_write_b32 a159, v43
    v_accvgpr_read_b32 v16, a64
    v_accvgpr_read_b32 v17, a65
    v_accvgpr_read_b32 v18, a66
    v_accvgpr_read_b32 v19, a67
    v_accvgpr_read_b32 v20, a68
    v_accvgpr_read_b32 v21, a69
    v_accvgpr_read_b32 v22, a70
    v_accvgpr_read_b32 v23, a71
    v_mul_f32 v16, s3, v16
    v_mul_f32 v17, s3, v17
    v_mul_f32 v18, s3, v18
    v_mul_f32 v19, s3, v19
    v_mul_f32 v20, s3, v20
    v_mul_f32 v21, s3, v21
    v_mul_f32 v22, s3, v22
    v_mul_f32 v23, s3, v23
    v_cvt_pk_bf16_f32 v36, v16, v17
    v_cvt_pk_bf16_f32 v37, v18, v19
    v_cvt_pk_bf16_f32 v38, v20, v21
    v_cvt_pk_bf16_f32 v39, v22, v23
    s_nop 0
    v_permlane32_swap_b32 v36, v38
    v_permlane32_swap_b32 v37, v39
    s_nop 0
    v_permlane16_swap_b32 v36, v38
    v_permlane16_swap_b32 v37, v39
    v_accvgpr_write_b32 a160, v36
    v_accvgpr_write_b32 a161, v37
    v_accvgpr_write_b32 a162, v38
    v_accvgpr_write_b32 a163, v39
    v_accvgpr_read_b32 v24, a72
    v_accvgpr_read_b32 v25, a73
    v_accvgpr_read_b32 v26, a74
    v_accvgpr_read_b32 v27, a75
    v_accvgpr_read_b32 v28, a76
    v_accvgpr_read_b32 v29, a77
    v_accvgpr_read_b32 v30, a78
    v_accvgpr_read_b32 v31, a79
    v_mul_f32 v24, s3, v24
    v_mul_f32 v25, s3, v25
    v_mul_f32 v26, s3, v26
    v_mul_f32 v27, s3, v27
    v_mul_f32 v28, s3, v28
    v_mul_f32 v29, s3, v29
    v_mul_f32 v30, s3, v30
    v_mul_f32 v31, s3, v31
    v_cvt_pk_bf16_f32 v40, v24, v25
    v_cvt_pk_bf16_f32 v41, v26, v27
    v_cvt_pk_bf16_f32 v42, v28, v29
    v_cvt_pk_bf16_f32 v43, v30, v31
    s_nop 0
    v_permlane32_swap_b32 v40, v42
    v_permlane32_swap_b32 v41, v43
    s_nop 0
    v_permlane16_swap_b32 v40, v42
    v_permlane16_swap_b32 v41, v43
    v_accvgpr_write_b32 a164, v40
    v_accvgpr_write_b32 a165, v41
    v_accvgpr_write_b32 a166, v42
    v_accvgpr_write_b32 a167, v43
    v_accvgpr_read_b32 v16, a80
    v_accvgpr_read_b32 v17, a81
    v_accvgpr_read_b32 v18, a82
    v_accvgpr_read_b32 v19, a83
    v_accvgpr_read_b32 v20, a84
    v_accvgpr_read_b32 v21, a85
    v_accvgpr_read_b32 v22, a86
    v_accvgpr_read_b32 v23, a87
    v_mul_f32 v16, s3, v16
    v_mul_f32 v17, s3, v17
    v_mul_f32 v18, s3, v18
    v_mul_f32 v19, s3, v19
    v_mul_f32 v20, s3, v20
    v_mul_f32 v21, s3, v21
    v_mul_f32 v22, s3, v22
    v_mul_f32 v23, s3, v23
    v_cvt_pk_bf16_f32 v36, v16, v17
    v_cvt_pk_bf16_f32 v37, v18, v19
    v_cvt_pk_bf16_f32 v38, v20, v21
    v_cvt_pk_bf16_f32 v39, v22, v23
    s_nop 0
    v_permlane32_swap_b32 v36, v38
    v_permlane32_swap_b32 v37, v39
    s_nop 0
    v_permlane16_swap_b32 v36, v38
    v_permlane16_swap_b32 v37, v39
    v_accvgpr_write_b32 a168, v36
    v_accvgpr_write_b32 a169, v37
    v_accvgpr_write_b32 a170, v38
    v_accvgpr_write_b32 a171, v39
    v_accvgpr_read_b32 v24, a88
    v_accvgpr_read_b32 v25, a89
    v_accvgpr_read_b32 v26, a90
    v_accvgpr_read_b32 v27, a91
    v_accvgpr_read_b32 v28, a92
    v_accvgpr_read_b32 v29, a93
    v_accvgpr_read_b32 v30, a94
    v_accvgpr_read_b32 v31, a95
    v_mul_f32 v24, s3, v24
    v_mul_f32 v25, s3, v25
    v_mul_f32 v26, s3, v26
    v_mul_f32 v27, s3, v27
    v_mul_f32 v28, s3, v28
    v_mul_f32 v29, s3, v29
    v_mul_f32 v30, s3, v30
    v_mul_f32 v31, s3, v31
    v_cvt_pk_bf16_f32 v40, v24, v25
    v_cvt_pk_bf16_f32 v41, v26, v27
    v_cvt_pk_bf16_f32 v42, v28, v29
    v_cvt_pk_bf16_f32 v43, v30, v31
    s_nop 0
    v_permlane32_swap_b32 v40, v42
    v_permlane32_swap_b32 v41, v43
    s_nop 0
    v_permlane16_swap_b32 v40, v42
    v_permlane16_swap_b32 v41, v43
    v_accvgpr_write_b32 a172, v40
    v_accvgpr_write_b32 a173, v41
    v_accvgpr_write_b32 a174, v42
    v_accvgpr_write_b32 a175, v43
    s_mov_b32 s40, 42240
    s_mov_b32 s41, 50688
    s_mov_b32 s42, 59136
    s_mov_b32 s43, 67584
    s_mov_b32 s38, 16384
    v_accvgpr_write_b32 a0, 0
    v_accvgpr_write_b32 a1, 0
    v_accvgpr_write_b32 a2, 0
    v_accvgpr_write_b32 a3, 0
    v_accvgpr_write_b32 a4, 0
    v_accvgpr_write_b32 a5, 0
    v_accvgpr_write_b32 a6, 0
    v_accvgpr_write_b32 a7, 0
    v_accvgpr_write_b32 a8, 0
    v_accvgpr_write_b32 a9, 0
    v_accvgpr_write_b32 a10, 0
    v_accvgpr_write_b32 a11, 0
    v_accvgpr_write_b32 a12, 0
    v_accvgpr_write_b32 a13, 0
    v_accvgpr_write_b32 a14, 0
    v_accvgpr_write_b32 a15, 0
    v_accvgpr_write_b32 a16, 0
    v_accvgpr_write_b32 a17, 0
    v_accvgpr_write_b32 a18, 0
    v_accvgpr_write_b32 a19, 0
    v_accvgpr_write_b32 a20, 0
    v_accvgpr_write_b32 a21, 0
    v_accvgpr_write_b32 a22, 0
    v_accvgpr_write_b32 a23, 0
    v_accvgpr_write_b32 a24, 0
    v_accvgpr_write_b32 a25, 0
    v_accvgpr_write_b32 a26, 0
    v_accvgpr_write_b32 a27, 0
    v_accvgpr_write_b32 a28, 0
    v_accvgpr_write_b32 a29, 0
    v_accvgpr_write_b32 a30, 0
    v_accvgpr_write_b32 a31, 0
    v_accvgpr_write_b32 a32, 0
    v_accvgpr_write_b32 a33, 0
    v_accvgpr_write_b32 a34, 0
    v_accvgpr_write_b32 a35, 0
    v_accvgpr_write_b32 a36, 0
    v_accvgpr_write_b32 a37, 0
    v_accvgpr_write_b32 a38, 0
    v_accvgpr_write_b32 a39, 0
    v_accvgpr_write_b32 a40, 0
    v_accvgpr_write_b32 a41, 0
    v_accvgpr_write_b32 a42, 0
    v_accvgpr_write_b32 a43, 0
    v_accvgpr_write_b32 a44, 0
    v_accvgpr_write_b32 a45, 0
    v_accvgpr_write_b32 a46, 0
    v_accvgpr_write_b32 a47, 0
    v_accvgpr_write_b32 a48, 0
    v_accvgpr_write_b32 a49, 0
    v_accvgpr_write_b32 a50, 0
    v_accvgpr_write_b32 a51, 0
    v_accvgpr_write_b32 a52, 0
    v_accvgpr_write_b32 a53, 0
    v_accvgpr_write_b32 a54, 0
    v_accvgpr_write_b32 a55, 0
    v_accvgpr_write_b32 a56, 0
    v_accvgpr_write_b32 a57, 0
    v_accvgpr_write_b32 a58, 0
    v_accvgpr_write_b32 a59, 0
    v_accvgpr_write_b32 a60, 0
    v_accvgpr_write_b32 a61, 0
    v_accvgpr_write_b32 a62, 0
    v_accvgpr_write_b32 a63, 0
    v_accvgpr_write_b32 a64, 0
    v_accvgpr_write_b32 a65, 0
    v_accvgpr_write_b32 a66, 0
    v_accvgpr_write_b32 a67, 0
    v_accvgpr_write_b32 a68, 0
    v_accvgpr_write_b32 a69, 0
    v_accvgpr_write_b32 a70, 0
    v_accvgpr_write_b32 a71, 0
    v_accvgpr_write_b32 a72, 0
    v_accvgpr_write_b32 a73, 0
    v_accvgpr_write_b32 a74, 0
    v_accvgpr_write_b32 a75, 0
    v_accvgpr_write_b32 a76, 0
    v_accvgpr_write_b32 a77, 0
    v_accvgpr_write_b32 a78, 0
    v_accvgpr_write_b32 a79, 0
    v_accvgpr_write_b32 a80, 0
    v_accvgpr_write_b32 a81, 0
    v_accvgpr_write_b32 a82, 0
    v_accvgpr_write_b32 a83, 0
    v_accvgpr_write_b32 a84, 0
    v_accvgpr_write_b32 a85, 0
    v_accvgpr_write_b32 a86, 0
    v_accvgpr_write_b32 a87, 0
    v_accvgpr_write_b32 a88, 0
    v_accvgpr_write_b32 a89, 0
    v_accvgpr_write_b32 a90, 0
    v_accvgpr_write_b32 a91, 0
    v_accvgpr_write_b32 a92, 0
    v_accvgpr_write_b32 a93, 0
    v_accvgpr_write_b32 a94, 0
    v_accvgpr_write_b32 a95, 0
    v_accvgpr_write_b32 a96, 0
    v_accvgpr_write_b32 a97, 0
    v_accvgpr_write_b32 a98, 0
    v_accvgpr_write_b32 a99, 0
    v_accvgpr_write_b32 a100, 0
    v_accvgpr_write_b32 a101, 0
    v_accvgpr_write_b32 a102, 0
    v_accvgpr_write_b32 a103, 0
    v_accvgpr_write_b32 a104, 0
    v_accvgpr_write_b32 a105, 0
    v_accvgpr_write_b32 a106, 0
    v_accvgpr_write_b32 a107, 0
    v_accvgpr_write_b32 a108, 0
    v_accvgpr_write_b32 a109, 0
    v_accvgpr_write_b32 a110, 0
    v_accvgpr_write_b32 a111, 0
    v_accvgpr_write_b32 a112, 0
    v_accvgpr_write_b32 a113, 0
    v_accvgpr_write_b32 a114, 0
    v_accvgpr_write_b32 a115, 0
    v_accvgpr_write_b32 a116, 0
    v_accvgpr_write_b32 a117, 0
    v_accvgpr_write_b32 a118, 0
    v_accvgpr_write_b32 a119, 0
    v_accvgpr_write_b32 a120, 0
    v_accvgpr_write_b32 a121, 0
    v_accvgpr_write_b32 a122, 0
    v_accvgpr_write_b32 a123, 0
    v_accvgpr_write_b32 a124, 0
    v_accvgpr_write_b32 a125, 0
    v_accvgpr_write_b32 a126, 0
    v_accvgpr_write_b32 a127, 0
    v_mov_b32 v68, 0
    v_mov_b32 v69, 0
    v_mov_b32 v70, 0
    v_mov_b32 v71, 0
    v_mov_b32 v42, 0
    v_mov_b32 v43, 0
    v_mov_b32 v78, 0
    v_mov_b32 v79, 0
    s_waitcnt lgkmcnt(0)
    s_mov_b32 s37, 0
    s_mov_b32 s44, s40
    s_mov_b32 s45, s41
    s_mov_b32 s46, s42
    s_mov_b32 s47, s43
    s_add_u32 s40, s47, 8448
    s_cmp_eq_u32 s40, 76032
    s_cselect_b32 s40, 0, s40
    s_add_u32 s41, s40, 8448
    s_cmp_eq_u32 s41, 76032
    s_cselect_b32 s41, 0, s41
    s_add_u32 s42, s41, 8448
    s_cmp_eq_u32 s42, 76032
    s_cselect_b32 s42, 0, s42
    s_add_u32 s43, s42, 8448
    s_cmp_eq_u32 s43, 76032
    s_cselect_b32 s43, 0, s43
    s_cmp_eq_u32 s30, 0
    s_cselect_b32 s48, s40, s41
    s_cselect_b32 s49, s41, s40
    s_cselect_b32 s50, s42, s43
    s_cselect_b32 s51, s43, s42
    s_sub_u32 s60, s48, s52
    s_mov_b32 s52, s48
    v_add_u32 v72, s60, v72
    v_add_u32 v73, s60, v73
    s_add_u32 s54, s38, 8192
    s_add_u32 s55, s38, 16384
    s_nop 9
L_attn:
    s_waitcnt vmcnt(2)
    s_barrier
    ds_read_b128 v[44:47], v72 offset:0
    ds_read_b128 v[60:63], v77 offset:0
    ds_read_b128 v[48:51], v72 offset:256
    ds_read_b128 v[64:67], v77 offset:1024
    ds_read_b128 v[52:55], v72 offset:512
    ds_read_b128 v[56:59], v72 offset:768
    s_cmp_ge_u32 s2, 256
    s_cbranch_scc1 L_alt3
    s_bitcmp1_b32 s37, 0
    s_cbranch_scc1 L_alt1
    s_setprio 2
    s_branch L_alt2
L_alt1:
    s_setprio 0
    s_branch L_alt2
L_alt3:
    s_setprio 1
L_alt2:
    s_add_u32 m0, s32, s44
    s_nop 0
    buffer_load_dwordx4 v76, s[16:19], s54 offen nt lds
    s_add_u32 m0, m0, 32
    s_nop 0
    buffer_load_dwordx4 v76, s[16:19], s54 offen offset:1024 nt lds
    s_waitcnt lgkmcnt(5)
    v_mfma_f32_16x16x32_bf16 v[0:3], v[44:47], a[128:131], 0
    v_mfma_f32_16x16x32_bf16 v[8:11], v[44:47], a[144:147], 0
    v_mfma_f32_16x16x32_bf16 v[16:19], v[44:47], a[160:163], 0
    s_waitcnt lgkmcnt(4)
    v_mfma_f32_16x16x32_bf16 v[24:27], v[44:47], v[60:63], 0
    ds_read_b128 v[60:63], v77 offset:2048
    ds_read_b128 v[44:47], v73 offset:0
    s_waitcnt lgkmcnt(5)
    v_mfma_f32_16x16x32_bf16 v[0:3], v[48:51], a[132:135], v[0:3]
    v_mfma_f32_16x16x32_bf16 v[8:11], v[48:51], a[148:151], v[8:11]
    v_mfma_f32_16x16x32_bf16 v[16:19], v[48:51], a[164:167], v[16:19]
    s_waitcnt lgkmcnt(4)
    v_mfma_f32_16x16x32_bf16 v[24:27], v[48:51], v[64:67], v[24:27]
    ds_read_b128 v[64:67], v77 offset:3072
    ds_read_b128 v[48:51], v73 offset:256
    s_add_u32 m0, s32, s45
    s_nop 0
    buffer_load_dwordx4 v76, s[20:23], s38 offen nt lds
    s_add_u32 m0, m0, 32
    s_nop 0
    buffer_load_dwordx4 v76, s[20:23], s38 offen offset:1024 nt lds
    s_waitcnt lgkmcnt(5)
    v_mfma_f32_16x16x32_bf16 v[0:3], v[52:55], a[136:139], v[0:3]
    v_mfma_f32_16x16x32_bf16 v[8:11], v[52:55], a[152:155], v[8:11]
    v_mfma_f32_16x16x32_bf16 v[16:19], v[52:55], a[168:171], v[16:19]
    s_waitcnt lgkmcnt(3)
    v_mfma_f32_16x16x32_bf16 v[24:27], v[52:55], v[60:63], v[24:27]
    ds_read_b128 v[52:55], v73 offset:512
    v_mfma_f32_16x16x32_bf16 v[0:3], v[56:59], a[140:143], v[0:3]
    v_mfma_f32_16x16x32_bf16 v[8:11], v[56:59], a[156:159], v[8:11]
    v_mfma_f32_16x16x32_bf16 v[16:19], v[56:59], a[172:175], v[16:19]
    s_waitcnt lgkmcnt(2)
    v_mfma_f32_16x16x32_bf16 v[24:27], v[56:59], v[64:67], v[24:27]
    ds_read_b128 v[56:59], v73 offset:768
    s_sub_u32 s60, s49, s52
    s_mov_b32 s52, s49
    v_add_u32 v72, s60, v72
    v_add_u32 v73, s60, v73
    s_sub_u32 s61, s50, s53
    s_mov_b32 s53, s50
    v_add_u32 v74, s61, v74
    v_add_u32 v75, s61, v75
    ds_read_b64_tr_b16 v[60:61], v74 offset:0
    ds_read_b64_tr_b16 v[62:63], v75 offset:0
    ds_read_b64_tr_b16 v[64:65], v74 offset:32
    ds_read_b64_tr_b16 v[66:67], v75 offset:32
    v_mfma_f32_16x16x32_bf16 v[4:7], v[44:47], a[128:131], 0
    s_waitcnt lgkmcnt(6)
    v_mfma_f32_16x16x32_bf16 v[4:7], v[48:51], a[132:135], v[4:7]
    v_exp_f32 v0, v0
    v_exp_f32 v1, v1
    s_waitcnt lgkmcnt(5)
    v_mfma_f32_16x16x32_bf16 v[4:7], v[52:55], a[136:139], v[4:7]
    v_exp_f32 v2, v2
    v_exp_f32 v3, v3
    s_waitcnt lgkmcnt(4)
    v_mfma_f32_16x16x32_bf16 v[4:7], v[56:59], a[140:143], v[4:7]
    v_cvt_pk_bf16_f32 v28, v0, v1
    v_cvt_pk_bf16_f32 v29, v2, v3
    s_add_u32 m0, s32, s46
    s_nop 0
    buffer_load_dwordx4 v76, s[20:23], s54 offen nt lds
    s_add_u32 m0, m0, 32
    s_nop 0
    buffer_load_dwordx4 v76, s[20:23], s54 offen offset:1024 nt lds
    v_mfma_f32_16x16x32_bf16 v[12:15], v[44:47], a[144:147], 0
    v_exp_f32 v8, v8
    v_exp_f32 v9, v9
    v_mfma_f32_16x16x32_bf16 v[12:15], v[48:51], a[148:151], v[12:15]
    v_exp_f32 v10, v10
    v_exp_f32 v11, v11
    v_mfma_f32_16x16x32_bf16 v[12:15], v[52:55], a[152:155], v[12:15]
    v_cvt_pk_bf16_f32 v32, v8, v9
    v_cvt_pk_bf16_f32 v33, v10, v11
    v_mfma_f32_16x16x32_bf16 v[12:15], v[56:59], a[156:159], v[12:15]
    v_exp_f32 v16, v16
    v_exp_f32 v17, v17
    v_mfma_f32_16x16x32_bf16 v[20:23], v[44:47], a[160:163], 0
    ds_read_b64_tr_b16 v[44:45], v74 offset:256
    ds_read_b64_tr_b16 v[46:47], v75 offset:256
    v_exp_f32 v18, v18
    v_exp_f32 v19, v19
    v_mfma_f32_16x16x32_bf16 v[20:23], v[48:51], a[164:167], v[20:23]
    ds_read_b64_tr_b16 v[48:49], v74 offset:288
    ds_read_b64_tr_b16 v[50:51], v75 offset:288
    v_cvt_pk_bf16_f32 v36, v16, v17
    v_cvt_pk_bf16_f32 v37, v18, v19
    v_mfma_f32_16x16x32_bf16 v[20:23], v[52:55], a[168:171], v[20:23]
    ds_read_b64_tr_b16 v[52:53], v74 offset:512
    ds_read_b64_tr_b16 v[54:55], v75 offset:512
    v_exp_f32 v24, v24
    v_exp_f32 v25, v25
    v_mfma_f32_16x16x32_bf16 v[20:23], v[56:59], a[172:175], v[20:23]
    ds_read_b64_tr_b16 v[56:57], v74 offset:544
    ds_read_b64_tr_b16 v[58:59], v75 offset:544
    v_exp_f32 v26, v26
    v_exp_f32 v27, v27
    v_cvt_pk_bf16_f32 v40, v24, v25
    v_cvt_pk_bf16_f32 v41, v26, v27
    v_exp_f32 v4, v4
    v_exp_f32 v5, v5
    v_exp_f32 v6, v6
    v_exp_f32 v7, v7
    v_cvt_pk_bf16_f32 v30, v4, v5
    v_cvt_pk_bf16_f32 v31, v6, v7
    s_waitcnt lgkmcnt(10)
    s_nop 0
    v_mfma_f32_16x16x32_bf16 a[0:3], v[60:63], v[28:31], a[0:3]
    v_exp_f32 v12, v12
    v_exp_f32 v13, v13
    s_waitcnt lgkmcnt(8)
    v_mfma_f32_16x16x32_bf16 a[4:7], v[64:67], v[28:31], a[4:7]
    v_exp_f32 v14, v14
    v_exp_f32 v15, v15
    v_cvt_pk_bf16_f32 v34, v12, v13
    v_cvt_pk_bf16_f32 v35, v14, v15
    s_nop 1
    v_mfma_f32_16x16x32_bf16 a[32:35], v[60:63], v[32:35], a[32:35]
    v_exp_f32 v20, v20
    v_exp_f32 v21, v21
    v_mfma_f32_16x16x32_bf16 a[36:39], v[64:67], v[32:35], a[36:39]
    v_exp_f32 v22, v22
    v_exp_f32 v23, v23
    v_cvt_pk_bf16_f32 v38, v20, v21
    v_cvt_pk_bf16_f32 v39, v22, v23
    s_nop 1
    v_mfma_f32_16x16x32_bf16 a[64:67], v[60:63], v[36:39], a[64:67]
    v_add_f32 v68, v68, v0
    v_add_f32 v68, v68, v1
    v_mfma_f32_16x16x32_bf16 a[68:71], v[64:67], v[36:39], a[68:71]
    v_add_f32 v68, v68, v2
    v_add_f32 v68, v68, v3
    v_mfma_f32_16x16x16_bf16 a[96:99], v[60:61], v[40:41], a[96:99]
    v_add_f32 v69, v69, v8
    v_add_f32 v69, v69, v9
    v_mfma_f32_16x16x16_bf16 a[100:103], v[64:65], v[40:41], a[100:103]
    v_add_f32 v69, v69, v10
    v_add_f32 v69, v69, v11
    ds_read_b64_tr_b16 v[60:61], v74 offset:768
    ds_read_b64_tr_b16 v[62:63], v75 offset:768
    ds_read_b64_tr_b16 v[64:65], v74 offset:800
    ds_read_b64_tr_b16 v[66:67], v75 offset:800
    s_waitcnt lgkmcnt(10)
    v_mfma_f32_16x16x32_bf16 a[8:11], v[44:47], v[28:31], a[8:11]
    v_add_f32 v70, v70, v16
    s_waitcnt lgkmcnt(8)
    v_mfma_f32_16x16x32_bf16 a[12:15], v[48:51], v[28:31], a[12:15]
    v_add_f32 v70, v70, v17
    v_mfma_f32_16x16x32_bf16 a[40:43], v[44:47], v[32:35], a[40:43]
    v_add_f32 v70, v70, v18
    v_mfma_f32_16x16x32_bf16 a[44:47], v[48:51], v[32:35], a[44:47]
    v_add_f32 v70, v70, v19
    v_mfma_f32_16x16x32_bf16 a[72:75], v[44:47], v[36:39], a[72:75]
    v_add_f32 v71, v71, v24
    v_mfma_f32_16x16x32_bf16 a[76:79], v[48:51], v[36:39], a[76:79]
    v_add_f32 v71, v71, v25
    v_mfma_f32_16x16x16_bf16 a[104:107], v[44:45], v[40:41], a[104:107]
    v_add_f32 v71, v71, v26
    v_mfma_f32_16x16x16_bf16 a[108:111], v[48:49], v[40:41], a[108:111]
    v_add_f32 v71, v71, v27
    ds_read_b128 v[44:47], v72 offset:0
    ds_read_b128 v[48:51], v72 offset:256
    s_waitcnt lgkmcnt(8)
    v_mfma_f32_16x16x32_bf16 a[16:19], v[52:55], v[28:31], a[16:19]
    v_add_f32 v68, v68, v4
    s_waitcnt lgkmcnt(6)
    v_mfma_f32_16x16x32_bf16 a[20:23], v[56:59], v[28:31], a[20:23]
    v_add_f32 v68, v68, v5
    v_mfma_f32_16x16x32_bf16 a[48:51], v[52:55], v[32:35], a[48:51]
    v_add_f32 v68, v68, v6
    v_mfma_f32_16x16x32_bf16 a[52:55], v[56:59], v[32:35], a[52:55]
    v_add_f32 v68, v68, v7
    v_mfma_f32_16x16x32_bf16 a[80:83], v[52:55], v[36:39], a[80:83]
    v_add_f32 v69, v69, v12
    v_mfma_f32_16x16x32_bf16 a[84:87], v[56:59], v[36:39], a[84:87]
    v_add_f32 v69, v69, v13
    v_mfma_f32_16x16x16_bf16 a[112:115], v[52:53], v[40:41], a[112:115]
    v_add_f32 v69, v69, v14
    v_mfma_f32_16x16x16_bf16 a[116:119], v[56:57], v[40:41], a[116:119]
    v_add_f32 v69, v69, v15
    ds_read_b128 v[52:55], v72 offset:512
    ds_read_b128 v[56:59], v72 offset:768
    s_waitcnt lgkmcnt(6)
    v_mfma_f32_16x16x32_bf16 a[24:27], v[60:63], v[28:31], a[24:27]
    v_add_f32 v70, v70, v20
    s_waitcnt lgkmcnt(4)
    v_mfma_f32_16x16x32_bf16 a[28:31], v[64:67], v[28:31], a[28:31]
    v_add_f32 v70, v70, v21
    v_mfma_f32_16x16x32_bf16 a[56:59], v[60:63], v[32:35], a[56:59]
    v_add_f32 v70, v70, v22
    v_mfma_f32_16x16x32_bf16 a[60:63], v[64:67], v[32:35], a[60:63]
    v_add_f32 v70, v70, v23
    v_mfma_f32_16x16x32_bf16 a[88:91], v[60:63], v[36:39], a[88:91]
    v_mfma_f32_16x16x32_bf16 a[92:95], v[64:67], v[36:39], a[92:95]
    v_mfma_f32_16x16x16_bf16 a[120:123], v[60:61], v[40:41], a[120:123]
    v_mfma_f32_16x16x16_bf16 a[124:127], v[64:65], v[40:41], a[124:127]
    s_waitcnt lgkmcnt(3)
    v_mfma_f32_16x16x32_bf16 v[0:3], v[44:47], a[128:131], 0
    v_mfma_f32_16x16x32_bf16 v[8:11], v[44:47], a[144:147], 0
    v_mfma_f32_16x16x32_bf16 v[16:19], v[44:47], a[160:163], 0
    ds_read_b128 v[44:47], v73 offset:0
    s_waitcnt lgkmcnt(3)
    v_mfma_f32_16x16x32_bf16 v[0:3], v[48:51], a[132:135], v[0:3]
    v_mfma_f32_16x16x32_bf16 v[8:11], v[48:51], a[148:151], v[8:11]
    v_mfma_f32_16x16x32_bf16 v[16:19], v[48:51], a[164:167], v[16:19]
    ds_read_b128 v[48:51], v73 offset:256
    s_waitcnt lgkmcnt(3)
    v_mfma_f32_16x16x32_bf16 v[0:3], v[52:55], a[136:139], v[0:3]
    v_mfma_f32_16x16x32_bf16 v[8:11], v[52:55], a[152:155], v[8:11]
    v_mfma_f32_16x16x32_bf16 v[16:19], v[52:55], a[168:171], v[16:19]
    ds_read_b128 v[52:55], v73 offset:512
    s_waitcnt lgkmcnt(3)
    v_mfma_f32_16x16x32_bf16 v[0:3], v[56:59], a[140:143], v[0:3]
    v_mfma_f32_16x16x32_bf16 v[8:11], v[56:59], a[156:159], v[8:11]
    v_mfma_f32_16x16x32_bf16 v[16:19], v[56:59], a[172:175], v[16:19]
    ds_read_b128 v[56:59], v73 offset:768
    s_sub_u32 s61, s51, s53
    s_mov_b32 s53, s51
    v_add_u32 v74, s61, v74
    v_add_u32 v75, s61, v75
    ds_read_b64_tr_b16 v[60:61], v74 offset:0
    ds_read_b64_tr_b16 v[62:63], v75 offset:0
    ds_read_b64_tr_b16 v[64:65], v74 offset:32
    ds_read_b64_tr_b16 v[66:67], v75 offset:32
    s_waitcnt lgkmcnt(7)
    v_mfma_f32_16x16x32_bf16 v[4:7], v[44:47], a[128:131], 0
    s_waitcnt lgkmcnt(6)
    v_mfma_f32_16x16x32_bf16 v[4:7], v[48:51], a[132:135], v[4:7]
    v_exp_f32 v0, v0
    v_exp_f32 v1, v1
    s_waitcnt lgkmcnt(5)
    v_mfma_f32_16x16x32_bf16 v[4:7], v[52:55], a[136:139], v[4:7]
    v_exp_f32 v2, v2
    v_exp_f32 v3, v3
    s_waitcnt lgkmcnt(4)
    v_mfma_f32_16x16x32_bf16 v[4:7], v[56:59], a[140:143], v[4:7]
    v_cvt_pk_bf16_f32 v28, v0, v1
    v_cvt_pk_bf16_f32 v29, v2, v3
    v_mfma_f32_16x16x32_bf16 v[12:15], v[44:47], a[144:147], 0
    v_exp_f32 v8, v8
    v_exp_f32 v9, v9
    v_mfma_f32_16x16x32_bf16 v[12:15], v[48:51], a[148:151], v[12:15]
    v_exp_f32 v10, v10
    v_exp_f32 v11, v11
    v_mfma_f32_16x16x32_bf16 v[12:15], v[52:55], a[152:155], v[12:15]
    v_cvt_pk_bf16_f32 v32, v8, v9
    v_cvt_pk_bf16_f32 v33, v10, v11
    v_mfma_f32_16x16x32_bf16 v[12:15], v[56:59], a[156:159], v[12:15]
    v_exp_f32 v16, v16
    v_exp_f32 v17, v17
    v_mfma_f32_16x16x32_bf16 v[20:23], v[44:47], a[160:163], 0
    ds_read_b64_tr_b16 v[44:45], v74 offset:256
    ds_read_b64_tr_b16 v[46:47], v75 offset:256
    v_exp_f32 v18, v18
    v_exp_f32 v19, v19
    v_mfma_f32_16x16x32_bf16 v[20:23], v[48:51], a[164:167], v[20:23]
    ds_read_b64_tr_b16 v[48:49], v74 offset:288
    ds_read_b64_tr_b16 v[50:51], v75 offset:288
    v_cvt_pk_bf16_f32 v36, v16, v17
    v_cvt_pk_bf16_f32 v37, v18, v19
    v_mfma_f32_16x16x32_bf16 v[20:23], v[52:55], a[168:171], v[20:23]
    ds_read_b64_tr_b16 v[52:53], v74 offset:512
    ds_read_b64_tr_b16 v[54:55], v75 offset:512
    v_exp_f32 v4, v4
    v_exp_f32 v5, v5
    v_mfma_f32_16x16x32_bf16 v[20:23], v[56:59], a[172:175], v[20:23]
    ds_read_b64_tr_b16 v[56:57], v74 offset:544
    ds_read_b64_tr_b16 v[58:59], v75 offset:544
    v_exp_f32 v6, v6
    v_exp_f32 v7, v7
    v_cvt_pk_bf16_f32 v30, v4, v5
    v_cvt_pk_bf16_f32 v31, v6, v7
    s_waitcnt lgkmcnt(10)
    s_nop 0
    v_mfma_f32_16x16x32_bf16 a[0:3], v[60:63], v[28:31], a[0:3]
    v_exp_f32 v12, v12
    v_exp_f32 v13, v13
    s_waitcnt lgkmcnt(8)
    v_mfma_f32_16x16x32_bf16 a[4:7], v[64:67], v[28:31], a[4:7]
    v_exp_f32 v14, v14
    v_exp_f32 v15, v15
    v_cvt_pk_bf16_f32 v34, v12, v13
    v_cvt_pk_bf16_f32 v35, v14, v15
    s_nop 1
    v_mfma_f32_16x16x32_bf16 a[32:35], v[60:63], v[32:35], a[32:35]
    v_exp_f32 v20, v20
    v_exp_f32 v21, v21
    v_mfma_f32_16x16x32_bf16 a[36:39], v[64:67], v[32:35], a[36:39]
    v_exp_f32 v22, v22
    v_exp_f32 v23, v23
    v_cvt_pk_bf16_f32 v38, v20, v21
    v_cvt_pk_bf16_f32 v39, v22, v23
    s_nop 1
    v_mfma_f32_16x16x32_bf16 a[64:67], v[60:63], v[36:39], a[64:67]
    v_add_f32 v68, v68, v0
    v_add_f32 v68, v68, v1
    v_mfma_f32_16x16x32_bf16 a[68:71], v[64:67], v[36:39], a[68:71]
    v_add_f32 v68, v68, v2
    v_add_f32 v68, v68, v3
    ds_read_b64_tr_b16 v[60:61], v74 offset:768
    ds_read_b64_tr_b16 v[62:63], v75 offset:768
    ds_read_b64_tr_b16 v[64:65], v74 offset:800
    ds_read_b64_tr_b16 v[66:67], v75 offset:800
    s_add_u32 m0, s32, s47
    s_nop 0
    buffer_load_dwordx4 v76, s[16:19], s55 offen nt lds
    s_add_u32 m0, m0, 32
    s_nop 0
    buffer_load_dwordx4 v76, s[16:19], s55 offen offset:1024 nt lds
    s_waitcnt lgkmcnt(10)
    v_mfma_f32_16x16x32_bf16 a[8:11], v[44:47], v[28:31], a[8:11]
    v_add_f32 v69, v69, v8
    s_waitcnt lgkmcnt(8)
    v_mfma_f32_16x16x32_bf16 a[12:15], v[48:51], v[28:31], a[12:15]
    v_add_f32 v69, v69, v9
    v_mfma_f32_16x16x32_bf16 a[40:43], v[44:47], v[32:35], a[40:43]
    v_add_f32 v69, v69, v10
    v_mfma_f32_16x16x32_bf16 a[44:47], v[48:51], v[32:35], a[44:47]
    v_add_f32 v69, v69, v11
    v_mfma_f32_16x16x32_bf16 a[72:75], v[44:47], v[36:39], a[72:75]
    v_add_f32 v70, v70, v16
    v_mfma_f32_16x16x32_bf16 a[76:79], v[48:51], v[36:39], a[76:79]
    v_add_f32 v70, v70, v17
    s_waitcnt lgkmcnt(6)
    v_mfma_f32_16x16x32_bf16 a[16:19], v[52:55], v[28:31], a[16:19]
    v_add_f32 v70, v70, v18
    s_waitcnt lgkmcnt(4)
    v_mfma_f32_16x16x32_bf16 a[20:23], v[56:59], v[28:31], a[20:23]
    v_add_f32 v70, v70, v19
    v_mfma_f32_16x16x32_bf16 a[48:51], v[52:55], v[32:35], a[48:51]
    v_add_f32 v68, v68, v4
    v_mfma_f32_16x16x32_bf16 a[52:55], v[56:59], v[32:35], a[52:55]
    v_add_f32 v68, v68, v5
    v_mfma_f32_16x16x32_bf16 a[80:83], v[52:55], v[36:39], a[80:83]
    v_add_f32 v68, v68, v6
    v_mfma_f32_16x16x32_bf16 a[84:87], v[56:59], v[36:39], a[84:87]
    v_add_f32 v68, v68, v7
    s_waitcnt lgkmcnt(2)
    v_mfma_f32_16x16x32_bf16 a[24:27], v[60:63], v[28:31], a[24:27]
    v_add_f32 v69, v69, v12
    s_waitcnt lgkmcnt(0)
    v_mfma_f32_16x16x32_bf16 a[28:31], v[64:67], v[28:31], a[28:31]
    v_add_f32 v69, v69, v13
    v_mfma_f32_16x16x32_bf16 a[56:59], v[60:63], v[32:35], a[56:59]
    v_add_f32 v69, v69, v14
    v_mfma_f32_16x16x32_bf16 a[60:63], v[64:67], v[32:35], a[60:63]
    v_add_f32 v69, v69, v15
    v_mfma_f32_16x16x32_bf16 a[88:91], v[60:63], v[36:39], a[88:91]
    v_add_f32 v70, v70, v20
    v_mfma_f32_16x16x32_bf16 a[92:95], v[64:67], v[36:39], a[92:95]
    v_add_f32 v70, v70, v21
    v_add_f32 v70, v70, v22
    v_add_f32 v70, v70, v23
    s_add_u32 s38, s38, 16384
    s_mov_b32 s44, s40
    s_mov_b32 s45, s41
    s_mov_b32 s46, s42
    s_mov_b32 s47, s43
    s_add_u32 s40, s47, 8448
    s_cmp_eq_u32 s40, 76032
    s_cselect_b32 s40, 0, s40
    s_add_u32 s41, s40, 8448
    s_cmp_eq_u32 s41, 76032
    s_cselect_b32 s41, 0, s41
    s_add_u32 s42, s41, 8448
    s_cmp_eq_u32 s42, 76032
    s_cselect_b32 s42, 0, s42
    s_add_u32 s43, s42, 8448
    s_cmp_eq_u32 s43, 76032
    s_cselect_b32 s43, 0, s43
    s_cmp_eq_u32 s30, 0
    s_cselect_b32 s48, s40, s41
    s_cselect_b32 s49, s41, s40
    s_cselect_b32 s50, s42, s43
    s_cselect_b32 s51, s43, s42
    s_sub_u32 s60, s48, s52
    s_mov_b32 s52, s48
    v_add_u32 v72, s60, v72
    v_add_u32 v73, s60, v73
    s_add_u32 s54, s38, 8192
    s_add_u32 s55, s38, 16384
    s_add_u32 s37, s37, 1
    s_cmp_lt_u32 s37, 16
    s_cbranch_scc1 L_attn
L_epi:
    s_nop 9
    s_waitcnt vmcnt(0)
    s_waitcnt lgkmcnt(0)
    s_barrier
    s_cmp_lg_u32 s56, 0
    s_cbranch_scc1 L_nopack1
    s_mov_b32 s8, s64
    s_and_b32 s9, s65, 0xffff
    s_mov_b32 s10, 5242880
    s_mov_b32 s11, 0x20000
    v_mbcnt_lo_u32_b32 v20, -1, 0
    v_mbcnt_hi_u32_b32 v20, -1, v20
    s_mul_i32 s70, s28, 5120
    s_add_u32 s70, s70, 36864
    v_add_u32 v21, 0, v20
    v_mul_u32_u24 v22, 205, v21
    v_lshrrev_b32 v22, 11, v22
    v_mul_u32_u24 v23, 10, v22
    v_sub_u32 v23, v21, v23
    v_mul_u32_u24 v24, 1280, v22
    v_lshl_add_u32 v24, v23, 4, v24
    s_add_u32 m0, s70, 0
    s_nop 0
    buffer_load_dwordx4 v24, s[8:11], s67 offen lds
    v_add_u32 v21, 64, v20
    v_mul_u32_u24 v22, 205, v21
    v_lshrrev_b32 v22, 11, v22
    v_mul_u32_u24 v23, 10, v22
    v_sub_u32 v23, v21, v23
    v_mul_u32_u24 v24, 1280, v22
    v_lshl_add_u32 v24, v23, 4, v24
    s_add_u32 m0, s70, 1024
    s_nop 0
    buffer_load_dwordx4 v24, s[8:11], s67 offen lds
    v_add_u32 v21, 128, v20
    v_mul_u32_u24 v22, 205, v21
    v_lshrrev_b32 v22, 11, v22
    v_mul_u32_u24 v23, 10, v22
    v_sub_u32 v23, v21, v23
    v_mul_u32_u24 v24, 1280, v22
    v_lshl_add_u32 v24, v23, 4, v24
    s_add_u32 m0, s70, 2048
    s_nop 0
    buffer_load_dwordx4 v24, s[8:11], s67 offen lds
    v_add_u32 v21, 192, v20
    v_mul_u32_u24 v22, 205, v21
    v_lshrrev_b32 v22, 11, v22
    v_mul_u32_u24 v23, 10, v22
    v_sub_u32 v23, v21, v23
    v_mul_u32_u24 v24, 1280, v22
    v_lshl_add_u32 v24, v23, 4, v24
    s_add_u32 m0, s70, 3072
    s_nop 0
    buffer_load_dwordx4 v24, s[8:11], s67 offen lds
    v_add_u32 v21, 256, v20
    v_mul_u32_u24 v22, 205, v21
    v_lshrrev_b32 v22, 11, v22
    v_mul_u32_u24 v23, 10, v22
    v_sub_u32 v23, v21, v23
    v_mul_u32_u24 v24, 1280, v22
    v_lshl_add_u32 v24, v23, 4, v24
    s_add_u32 m0, s70, 4096
    s_nop 0
    buffer_load_dwordx4 v24, s[8:11], s67 offen lds
L_nopack1:
    s_nop 9
    v_mbcnt_lo_u32_b32 v20, -1, 0
    v_mbcnt_hi_u32_b32 v20, -1, v20
    v_mov_b32 v21, v68
    s_nop 1
    v_permlane32_swap_b32 v68, v21
    v_add_f32 v68, v68, v21
    v_mov_b32 v21, v68
    s_nop 1
    v_permlane16_swap_b32 v68, v21
    v_add_f32 v68, v68, v21
    v_mov_b32 v21, v69
    s_nop 1
    v_permlane32_swap_b32 v69, v21
    v_add_f32 v69, v69, v21
    v_mov_b32 v21, v69
    s_nop 1
    v_permlane16_swap_b32 v69, v21
    v_add_f32 v69, v69, v21
    v_mov_b32 v21, v70
    s_nop 1
    v_permlane32_swap_b32 v70, v21
    v_add_f32 v70, v70, v21
    v_mov_b32 v21, v70
    s_nop 1
    v_permlane16_swap_b32 v70, v21
    v_add_f32 v70, v70, v21
    v_mov_b32 v21, v71
    s_nop 1
    v_permlane32_swap_b32 v71, v21
    v_add_f32 v71, v71, v21
    v_mov_b32 v21, v71
    s_nop 1
    v_permlane16_swap_b32 v71, v21
    v_add_f32 v71, v71, v21
    v_lshlrev_b32 v22, 4, v20
    s_mul_i32 s3, s28, 8704
    v_add_u32 v23, s3, v22
    ds_write_b128 v23, a[96:99] offset:0
    ds_write_b128 v23, a[100:103] offset:1024
    ds_write_b128 v23, a[104:107] offset:2048
    ds_write_b128 v23, a[108:111] offset:3072
    ds_write_b128 v23, a[112:115] offset:4096
    ds_write_b128 v23, a[116:119] offset:5120
    ds_write_b128 v23, a[120:123] offset:6144
    ds_write_b128 v23, a[124:127] offset:7168
    v_lshlrev_b32 v24, 2, v20
    v_add_u32 v25, s3, v24
    ds_write_b32 v25, v71 offset:8192
    ds_write_b32 v25, v79 offset:8448
    s_waitcnt lgkmcnt(0)
    s_barrier
    s_mov_b64 s[58:59], 0
    s_mov_b32 s6, 0xd800000
    s_mov_b32 s7, 0x71800000
    v_mov_b32 v26, 0
    s_lshl_b32 s4, s57, 12
    v_cmp_nle_f32 vcc, s6, v68
    s_nop 0
    s_or_b64 s[58:59], s[58:59], vcc
    v_cmp_nge_f32 vcc, s7, v68
    s_nop 0
    s_or_b64 s[58:59], s[58:59], vcc
    v_rcp_f32 v27, v68
    s_mul_i32 s5, s28, 393216
    s_add_u32 s5, s5, 0
    s_add_u32 s5, s5, s4
    v_accvgpr_read_b32 v28, a0
    v_accvgpr_read_b32 v29, a1
    v_accvgpr_read_b32 v30, a2
    v_accvgpr_read_b32 v31, a3
    v_accvgpr_read_b32 v32, a4
    v_accvgpr_read_b32 v33, a5
    v_accvgpr_read_b32 v34, a6
    v_accvgpr_read_b32 v35, a7
    v_mul_f32 v28, v28, v27
    v_mul_f32 v29, v29, v27
    v_mul_f32 v30, v30, v27
    v_mul_f32 v31, v31, v27
    v_mul_f32 v32, v32, v27
    v_mul_f32 v33, v33, v27
    v_mul_f32 v34, v34, v27
    v_mul_f32 v35, v35, v27
    v_fma_f32 v26, v28, 0, v26
    v_fma_f32 v26, v29, 0, v26
    v_fma_f32 v26, v30, 0, v26
    v_fma_f32 v26, v31, 0, v26
    v_fma_f32 v26, v32, 0, v26
    v_fma_f32 v26, v33, 0, v26
    v_fma_f32 v26, v34, 0, v26
    v_fma_f32 v26, v35, 0, v26
    v_cvt_pk_bf16_f32 v44, v28, v29
    v_cvt_pk_bf16_f32 v45, v30, v31
    v_cvt_pk_bf16_f32 v46, v32, v33
    v_cvt_pk_bf16_f32 v47, v34, v35
    buffer_store_dwordx4 v[44:47], v22, s[24:27], s5 offen sc1
    v_accvgpr_read_b32 v36, a8
    v_accvgpr_read_b32 v37, a9
    v_accvgpr_read_b32 v38, a10
    v_accvgpr_read_b32 v39, a11
    v_accvgpr_read_b32 v40, a12
    v_accvgpr_read_b32 v41, a13
    v_accvgpr_read_b32 v42, a14
    v_accvgpr_read_b32 v43, a15
    v_mul_f32 v36, v36, v27
    v_mul_f32 v37, v37, v27
    v_mul_f32 v38, v38, v27
    v_mul_f32 v39, v39, v27
    v_mul_f32 v40, v40, v27
    v_mul_f32 v41, v41, v27
    v_mul_f32 v42, v42, v27
    v_mul_f32 v43, v43, v27
    v_fma_f32 v26, v36, 0, v26
    v_fma_f32 v26, v37, 0, v26
    v_fma_f32 v26, v38, 0, v26
    v_fma_f32 v26, v39, 0, v26
    v_fma_f32 v26, v40, 0, v26
    v_fma_f32 v26, v41, 0, v26
    v_fma_f32 v26, v42, 0, v26
    v_fma_f32 v26, v43, 0, v26
    v_cvt_pk_bf16_f32 v48, v36, v37
    v_cvt_pk_bf16_f32 v49, v38, v39
    v_cvt_pk_bf16_f32 v50, v40, v41
    v_cvt_pk_bf16_f32 v51, v42, v43
    buffer_store_dwordx4 v[48:51], v22, s[24:27], s5 offen offset:1024 sc1
    v_accvgpr_read_b32 v28, a16
    v_accvgpr_read_b32 v29, a17
    v_accvgpr_read_b32 v30, a18
    v_accvgpr_read_b32 v31, a19
    v_accvgpr_read_b32 v32, a20
    v_accvgpr_read_b32 v33, a21
    v_accvgpr_read_b32 v34, a22
    v_accvgpr_read_b32 v35, a23
    v_mul_f32 v28, v28, v27
    v_mul_f32 v29, v29, v27
    v_mul_f32 v30, v30, v27
    v_mul_f32 v31, v31, v27
    v_mul_f32 v32, v32, v27
    v_mul_f32 v33, v33, v27
    v_mul_f32 v34, v34, v27
    v_mul_f32 v35, v35, v27
    v_fma_f32 v26, v28, 0, v26
    v_fma_f32 v26, v29, 0, v26
    v_fma_f32 v26, v30, 0, v26
    v_fma_f32 v26, v31, 0, v26
    v_fma_f32 v26, v32, 0, v26
    v_fma_f32 v26, v33, 0, v26
    v_fma_f32 v26, v34, 0, v26
    v_fma_f32 v26, v35, 0, v26
    v_cvt_pk_bf16_f32 v44, v28, v29
    v_cvt_pk_bf16_f32 v45, v30, v31
    v_cvt_pk_bf16_f32 v46, v32, v33
    v_cvt_pk_bf16_f32 v47, v34, v35
    buffer_store_dwordx4 v[44:47], v22, s[24:27], s5 offen offset:2048 sc1
    v_accvgpr_read_b32 v36, a24
    v_accvgpr_read_b32 v37, a25
    v_accvgpr_read_b32 v38, a26
    v_accvgpr_read_b32 v39, a27
    v_accvgpr_read_b32 v40, a28
    v_accvgpr_read_b32 v41, a29
    v_accvgpr_read_b32 v42, a30
    v_accvgpr_read_b32 v43, a31
    v_mul_f32 v36, v36, v27
    v_mul_f32 v37, v37, v27
    v_mul_f32 v38, v38, v27
    v_mul_f32 v39, v39, v27
    v_mul_f32 v40, v40, v27
    v_mul_f32 v41, v41, v27
    v_mul_f32 v42, v42, v27
    v_mul_f32 v43, v43, v27
    v_fma_f32 v26, v36, 0, v26
    v_fma_f32 v26, v37, 0, v26
    v_fma_f32 v26, v38, 0, v26
    v_fma_f32 v26, v39, 0, v26
    v_fma_f32 v26, v40, 0, v26
    v_fma_f32 v26, v41, 0, v26
    v_fma_f32 v26, v42, 0, v26
    v_fma_f32 v26, v43, 0, v26
    v_cvt_pk_bf16_f32 v48, v36, v37
    v_cvt_pk_bf16_f32 v49, v38, v39
    v_cvt_pk_bf16_f32 v50, v40, v41
    v_cvt_pk_bf16_f32 v51, v42, v43
    buffer_store_dwordx4 v[48:51], v22, s[24:27], s5 offen offset:3072 sc1
    v_cmp_nle_f32 vcc, s6, v69
    s_nop 0
    s_or_b64 s[58:59], s[58:59], vcc
    v_cmp_nge_f32 vcc, s7, v69
    s_nop 0
    s_or_b64 s[58:59], s[58:59], vcc
    v_rcp_f32 v27, v69
    s_mul_i32 s5, s28, 393216
    s_add_u32 s5, s5, 131072
    s_add_u32 s5, s5, s4
    v_accvgpr_read_b32 v28, a32
    v_accvgpr_read_b32 v29, a33
    v_accvgpr_read_b32 v30, a34
    v_accvgpr_read_b32 v31, a35
    v_accvgpr_read_b32 v32, a36
    v_accvgpr_read_b32 v33, a37
    v_accvgpr_read_b32 v34, a38
    v_accvgpr_read_b32 v35, a39
    v_mul_f32 v28, v28, v27
    v_mul_f32 v29, v29, v27
    v_mul_f32 v30, v30, v27
    v_mul_f32 v31, v31, v27
    v_mul_f32 v32, v32, v27
    v_mul_f32 v33, v33, v27
    v_mul_f32 v34, v34, v27
    v_mul_f32 v35, v35, v27
    v_fma_f32 v26, v28, 0, v26
    v_fma_f32 v26, v29, 0, v26
    v_fma_f32 v26, v30, 0, v26
    v_fma_f32 v26, v31, 0, v26
    v_fma_f32 v26, v32, 0, v26
    v_fma_f32 v26, v33, 0, v26
    v_fma_f32 v26, v34, 0, v26
    v_fma_f32 v26, v35, 0, v26
    v_cvt_pk_bf16_f32 v44, v28, v29
    v_cvt_pk_bf16_f32 v45, v30, v31
    v_cvt_pk_bf16_f32 v46, v32, v33
    v_cvt_pk_bf16_f32 v47, v34, v35
    buffer_store_dwordx4 v[44:47], v22, s[24:27], s5 offen sc1
    v_accvgpr_read_b32 v36, a40
    v_accvgpr_read_b32 v37, a41
    v_accvgpr_read_b32 v38, a42
    v_accvgpr_read_b32 v39, a43
    v_accvgpr_read_b32 v40, a44
    v_accvgpr_read_b32 v41, a45
    v_accvgpr_read_b32 v42, a46
    v_accvgpr_read_b32 v43, a47
    v_mul_f32 v36, v36, v27
    v_mul_f32 v37, v37, v27
    v_mul_f32 v38, v38, v27
    v_mul_f32 v39, v39, v27
    v_mul_f32 v40, v40, v27
    v_mul_f32 v41, v41, v27
    v_mul_f32 v42, v42, v27
    v_mul_f32 v43, v43, v27
    v_fma_f32 v26, v36, 0, v26
    v_fma_f32 v26, v37, 0, v26
    v_fma_f32 v26, v38, 0, v26
    v_fma_f32 v26, v39, 0, v26
    v_fma_f32 v26, v40, 0, v26
    v_fma_f32 v26, v41, 0, v26
    v_fma_f32 v26, v42, 0, v26
    v_fma_f32 v26, v43, 0, v26
    v_cvt_pk_bf16_f32 v48, v36, v37
    v_cvt_pk_bf16_f32 v49, v38, v39
    v_cvt_pk_bf16_f32 v50, v40, v41
    v_cvt_pk_bf16_f32 v51, v42, v43
    buffer_store_dwordx4 v[48:51], v22, s[24:27], s5 offen offset:1024 sc1
    v_accvgpr_read_b32 v28, a48
    v_accvgpr_read_b32 v29, a49
    v_accvgpr_read_b32 v30, a50
    v_accvgpr_read_b32 v31, a51
    v_accvgpr_read_b32 v32, a52
    v_accvgpr_read_b32 v33, a53
    v_accvgpr_read_b32 v34, a54
    v_accvgpr_read_b32 v35, a55
    v_mul_f32 v28, v28, v27
    v_mul_f32 v29, v29, v27
    v_mul_f32 v30, v30, v27
    v_mul_f32 v31, v31, v27
    v_mul_f32 v32, v32, v27
    v_mul_f32 v33, v33, v27
    v_mul_f32 v34, v34, v27
    v_mul_f32 v35, v35, v27
    v_fma_f32 v26, v28, 0, v26
    v_fma_f32 v26, v29, 0, v26
    v_fma_f32 v26, v30, 0, v26
    v_fma_f32 v26, v31, 0, v26
    v_fma_f32 v26, v32, 0, v26
    v_fma_f32 v26, v33, 0, v26
    v_fma_f32 v26, v34, 0, v26
    v_fma_f32 v26, v35, 0, v26
    v_cvt_pk_bf16_f32 v44, v28, v29
    v_cvt_pk_bf16_f32 v45, v30, v31
    v_cvt_pk_bf16_f32 v46, v32, v33
    v_cvt_pk_bf16_f32 v47, v34, v35
    buffer_store_dwordx4 v[44:47], v22, s[24:27], s5 offen offset:2048 sc1
    v_accvgpr_read_b32 v36, a56
    v_accvgpr_read_b32 v37, a57
    v_accvgpr_read_b32 v38, a58
    v_accvgpr_read_b32 v39, a59
    v_accvgpr_read_b32 v40, a60
    v_accvgpr_read_b32 v41, a61
    v_accvgpr_read_b32 v42, a62
    v_accvgpr_read_b32 v43, a63
    v_mul_f32 v36, v36, v27
    v_mul_f32 v37, v37, v27
    v_mul_f32 v38, v38, v27
    v_mul_f32 v39, v39, v27
    v_mul_f32 v40, v40, v27
    v_mul_f32 v41, v41, v27
    v_mul_f32 v42, v42, v27
    v_mul_f32 v43, v43, v27
    v_fma_f32 v26, v36, 0, v26
    v_fma_f32 v26, v37, 0, v26
    v_fma_f32 v26, v38, 0, v26
    v_fma_f32 v26, v39, 0, v26
    v_fma_f32 v26, v40, 0, v26
    v_fma_f32 v26, v41, 0, v26
    v_fma_f32 v26, v42, 0, v26
    v_fma_f32 v26, v43, 0, v26
    v_cvt_pk_bf16_f32 v48, v36, v37
    v_cvt_pk_bf16_f32 v49, v38, v39
    v_cvt_pk_bf16_f32 v50, v40, v41
    v_cvt_pk_bf16_f32 v51, v42, v43
    buffer_store_dwordx4 v[48:51], v22, s[24:27], s5 offen offset:3072 sc1
    v_cmp_nle_f32 vcc, s6, v70
    s_nop 0
    s_or_b64 s[58:59], s[58:59], vcc
    v_cmp_nge_f32 vcc, s7, v70
    s_nop 0
    s_or_b64 s[58:59], s[58:59], vcc
    v_rcp_f32 v27, v70
    s_mul_i32 s5, s28, 393216
    s_add_u32 s5, s5, 262144
    s_add_u32 s5, s5, s4
    v_accvgpr_read_b32 v28, a64
    v_accvgpr_read_b32 v29, a65
    v_accvgpr_read_b32 v30, a66
    v_accvgpr_read_b32 v31, a67
    v_accvgpr_read_b32 v32, a68
    v_accvgpr_read_b32 v33, a69
    v_accvgpr_read_b32 v34, a70
    v_accvgpr_read_b32 v35, a71
    v_mul_f32 v28, v28, v27
    v_mul_f32 v29, v29, v27
    v_mul_f32 v30, v30, v27
    v_mul_f32 v31, v31, v27
    v_mul_f32 v32, v32, v27
    v_mul_f32 v33, v33, v27
    v_mul_f32 v34, v34, v27
    v_mul_f32 v35, v35, v27
    v_fma_f32 v26, v28, 0, v26
    v_fma_f32 v26, v29, 0, v26
    v_fma_f32 v26, v30, 0, v26
    v_fma_f32 v26, v31, 0, v26
    v_fma_f32 v26, v32, 0, v26
    v_fma_f32 v26, v33, 0, v26
    v_fma_f32 v26, v34, 0, v26
    v_fma_f32 v26, v35, 0, v26
    v_cvt_pk_bf16_f32 v44, v28, v29
    v_cvt_pk_bf16_f32 v45, v30, v31
    v_cvt_pk_bf16_f32 v46, v32, v33
    v_cvt_pk_bf16_f32 v47, v34, v35
    buffer_store_dwordx4 v[44:47], v22, s[24:27], s5 offen sc1
    v_accvgpr_read_b32 v36, a72
    v_accvgpr_read_b32 v37, a73
    v_accvgpr_read_b32 v38, a74
    v_accvgpr_read_b32 v39, a75
    v_accvgpr_read_b32 v40, a76
    v_accvgpr_read_b32 v41, a77
    v_accvgpr_read_b32 v42, a78
    v_accvgpr_read_b32 v43, a79
    v_mul_f32 v36, v36, v27
    v_mul_f32 v37, v37, v27
    v_mul_f32 v38, v38, v27
    v_mul_f32 v39, v39, v27
    v_mul_f32 v40, v40, v27
    v_mul_f32 v41, v41, v27
    v_mul_f32 v42, v42, v27
    v_mul_f32 v43, v43, v27
    v_fma_f32 v26, v36, 0, v26
    v_fma_f32 v26, v37, 0, v26
    v_fma_f32 v26, v38, 0, v26
    v_fma_f32 v26, v39, 0, v26
    v_fma_f32 v26, v40, 0, v26
    v_fma_f32 v26, v41, 0, v26
    v_fma_f32 v26, v42, 0, v26
    v_fma_f32 v26, v43, 0, v26
    v_cvt_pk_bf16_f32 v48, v36, v37
    v_cvt_pk_bf16_f32 v49, v38, v39
    v_cvt_pk_bf16_f32 v50, v40, v41
    v_cvt_pk_bf16_f32 v51, v42, v43
    buffer_store_dwordx4 v[48:51], v22, s[24:27], s5 offen offset:1024 sc1
    v_accvgpr_read_b32 v28, a80
    v_accvgpr_read_b32 v29, a81
    v_accvgpr_read_b32 v30, a82
    v_accvgpr_read_b32 v31, a83
    v_accvgpr_read_b32 v32, a84
    v_accvgpr_read_b32 v33, a85
    v_accvgpr_read_b32 v34, a86
    v_accvgpr_read_b32 v35, a87
    v_mul_f32 v28, v28, v27
    v_mul_f32 v29, v29, v27
    v_mul_f32 v30, v30, v27
    v_mul_f32 v31, v31, v27
    v_mul_f32 v32, v32, v27
    v_mul_f32 v33, v33, v27
    v_mul_f32 v34, v34, v27
    v_mul_f32 v35, v35, v27
    v_fma_f32 v26, v28, 0, v26
    v_fma_f32 v26, v29, 0, v26
    v_fma_f32 v26, v30, 0, v26
    v_fma_f32 v26, v31, 0, v26
    v_fma_f32 v26, v32, 0, v26
    v_fma_f32 v26, v33, 0, v26
    v_fma_f32 v26, v34, 0, v26
    v_fma_f32 v26, v35, 0, v26
    v_cvt_pk_bf16_f32 v44, v28, v29
    v_cvt_pk_bf16_f32 v45, v30, v31
    v_cvt_pk_bf16_f32 v46, v32, v33
    v_cvt_pk_bf16_f32 v47, v34, v35
    buffer_store_dwordx4 v[44:47], v22, s[24:27], s5 offen offset:2048 sc1
    v_accvgpr_read_b32 v36, a88
    v_accvgpr_read_b32 v37, a89
    v_accvgpr_read_b32 v38, a90
    v_accvgpr_read_b32 v39, a91
    v_accvgpr_read_b32 v40, a92
    v_accvgpr_read_b32 v41, a93
    v_accvgpr_read_b32 v42, a94
    v_accvgpr_read_b32 v43, a95
    v_mul_f32 v36, v36, v27
    v_mul_f32 v37, v37, v27
    v_mul_f32 v38, v38, v27
    v_mul_f32 v39, v39, v27
    v_mul_f32 v40, v40, v27
    v_mul_f32 v41, v41, v27
    v_mul_f32 v42, v42, v27
    v_mul_f32 v43, v43, v27
    v_fma_f32 v26, v36, 0, v26
    v_fma_f32 v26, v37, 0, v26
    v_fma_f32 v26, v38, 0, v26
    v_fma_f32 v26, v39, 0, v26
    v_fma_f32 v26, v40, 0, v26
    v_fma_f32 v26, v41, 0, v26
    v_fma_f32 v26, v42, 0, v26
    v_fma_f32 v26, v43, 0, v26
    v_cvt_pk_bf16_f32 v48, v36, v37
    v_cvt_pk_bf16_f32 v49, v38, v39
    v_cvt_pk_bf16_f32 v50, v40, v41
    v_cvt_pk_bf16_f32 v51, v42, v43
    buffer_store_dwordx4 v[48:51], v22, s[24:27], s5 offen offset:3072 sc1
    s_lshl_b32 s3, s28, 11
    v_add_u32 v23, s3, v22
    ds_read_b32 v52, v24 offset:8192
    ds_read_b32 v56, v24 offset:8448
    ds_read_b32 v53, v24 offset:16896
    ds_read_b32 v57, v24 offset:17152
    ds_read_b32 v54, v24 offset:25600
    ds_read_b32 v58, v24 offset:25856
    ds_read_b32 v55, v24 offset:34304
    ds_read_b32 v59, v24 offset:34560
    s_waitcnt lgkmcnt(0)
    v_max3_f32 v60, v56, v57, v58
    v_max_f32 v60, v60, v59
    v_sub_f32 v56, v56, v60
    v_exp_f32 v56, v56
    v_sub_f32 v57, v57, v60
    v_exp_f32 v57, v57
    v_sub_f32 v58, v58, v60
    v_exp_f32 v58, v58
    v_sub_f32 v59, v59, v60
    v_exp_f32 v59, v59
    v_mul_f32 v61, v52, v56
    v_fma_f32 v61, v53, v57, v61
    v_fma_f32 v61, v54, v58, v61
    v_fma_f32 v61, v55, v59, v61
    v_cmp_nle_f32 vcc, s6, v61
    s_nop 0
    s_or_b64 s[58:59], s[58:59], vcc
    v_cmp_nge_f32 vcc, s7, v61
    s_nop 0
    s_or_b64 s[58:59], s[58:59], vcc
    v_rcp_f32 v27, v61
    s_nop 0
    v_mul_f32 v56, v56, v27
    v_mul_f32 v57, v57, v27
    v_mul_f32 v58, v58, v27
    v_mul_f32 v59, v59, v27
    ds_read_b128 v[0:3], v23 offset:0
    ds_read_b128 v[4:7], v23 offset:1024
    ds_read_b128 v[8:11], v23 offset:8704
    ds_read_b128 v[12:15], v23 offset:9728
    ds_read_b128 v[28:31], v23 offset:17408
    ds_read_b128 v[32:35], v23 offset:18432
    ds_read_b128 v[36:39], v23 offset:26112
    ds_read_b128 v[40:43], v23 offset:27136
    s_waitcnt lgkmcnt(0)
    v_mul_f32 v0, v0, v56
    v_fma_f32 v0, v8, v57, v0
    v_fma_f32 v0, v28, v58, v0
    v_fma_f32 v0, v36, v59, v0
    v_fma_f32 v26, v0, 0, v26
    v_mul_f32 v1, v1, v56
    v_fma_f32 v1, v9, v57, v1
    v_fma_f32 v1, v29, v58, v1
    v_fma_f32 v1, v37, v59, v1
    v_fma_f32 v26, v1, 0, v26
    v_mul_f32 v2, v2, v56
    v_fma_f32 v2, v10, v57, v2
    v_fma_f32 v2, v30, v58, v2
    v_fma_f32 v2, v38, v59, v2
    v_fma_f32 v26, v2, 0, v26
    v_mul_f32 v3, v3, v56
    v_fma_f32 v3, v11, v57, v3
    v_fma_f32 v3, v31, v58, v3
    v_fma_f32 v3, v39, v59, v3
    v_fma_f32 v26, v3, 0, v26
    v_mul_f32 v4, v4, v56
    v_fma_f32 v4, v12, v57, v4
    v_fma_f32 v4, v32, v58, v4
    v_fma_f32 v4, v40, v59, v4
    v_fma_f32 v26, v4, 0, v26
    v_mul_f32 v5, v5, v56
    v_fma_f32 v5, v13, v57, v5
    v_fma_f32 v5, v33, v58, v5
    v_fma_f32 v5, v41, v59, v5
    v_fma_f32 v26, v5, 0, v26
    v_mul_f32 v6, v6, v56
    v_fma_f32 v6, v14, v57, v6
    v_fma_f32 v6, v34, v58, v6
    v_fma_f32 v6, v42, v59, v6
    v_fma_f32 v26, v6, 0, v26
    v_mul_f32 v7, v7, v56
    v_fma_f32 v7, v15, v57, v7
    v_fma_f32 v7, v35, v58, v7
    v_fma_f32 v7, v43, v59, v7
    v_fma_f32 v26, v7, 0, v26
    v_cvt_pk_bf16_f32 v64, v0, v1
    v_cvt_pk_bf16_f32 v65, v2, v3
    v_cvt_pk_bf16_f32 v66, v4, v5
    v_cvt_pk_bf16_f32 v67, v6, v7
    s_lshl_b32 s5, s28, 10
    s_add_u32 s5, s5, 1572864
    s_add_u32 s5, s5, s4
    buffer_store_dwordx4 v[64:67], v22, s[24:27], s5 offen sc1
    s_cmp_lg_u32 s56, 0
    s_cbranch_scc1 L_nopack2
    s_waitcnt vmcnt(13)
    v_lshrrev_b32 v0, 2, v20
    v_mul_u32_u24 v0, 160, v0
    v_and_b32 v1, 3, v20
    v_lshl_add_u32 v0, v1, 3, v0
    v_add_u32 v0, s70, v0
    ds_read_b64_tr_b16 v[28:29], v0 offset:0
    ds_read_b64_tr_b16 v[30:31], v0 offset:2560
    ds_read_b64_tr_b16 v[32:33], v0 offset:32
    ds_read_b64_tr_b16 v[34:35], v0 offset:2592
    ds_read_b64_tr_b16 v[36:37], v0 offset:64
    ds_read_b64_tr_b16 v[38:39], v0 offset:2624
    ds_read_b64_tr_b16 v[40:41], v0 offset:96
    ds_read_b64_tr_b16 v[42:43], v0 offset:2656
    ds_read_b64_tr_b16 v[44:45], v0 offset:128
    ds_read_b64_tr_b16 v[46:47], v0 offset:2688
    s_mov_b32 s8, s68
    s_and_b32 s9, s69, 0xffff
    s_mov_b32 s10, 5120
    s_mov_b32 s11, 0x20000
    s_movk_i32 s3, 0x1000
    s_waitcnt lgkmcnt(0)
    buffer_store_dwordx4 v[28:31], v22, s[8:11], 0 offen sc1
    buffer_store_dwordx4 v[32:35], v22, s[8:11], 0 offen offset:1024 sc1
    buffer_store_dwordx4 v[36:39], v22, s[8:11], 0 offen offset:2048 sc1
    buffer_store_dwordx4 v[40:43], v22, s[8:11], 0 offen offset:3072 sc1
    buffer_store_dwordx4 v[44:47], v22, s[8:11], s3 offen sc1
L_nopack2:
    s_nop 9
    v_cmp_u_f32 vcc, v26, v26
    s_nop 0
    s_or_b64 s[58:59], s[58:59], vcc
    s_cmp_lg_u32 s56, 0
    s_cbranch_scc1 L_k1_end
    v_mov_b32 v9, 80128
    v_mov_b32 v10, 1
    s_cmp_eq_u64 s[58:59], 0
    s_cbranch_scc1 L_nobad
    ds_write_b32 v9, v10 offset:0
L_nobad:
    s_waitcnt lgkmcnt(0)
    s_barrier
    ds_read_b32 v10, v9 offset:0
    s_waitcnt lgkmcnt(0)
    v_readfirstlane_b32 s3, v10
    s_nop 1
    s_cmp_eq_u32 s3, 0
    s_cbranch_scc1 L_k1_end
    s_nop 9
    s_mov_b32 s56, 1
    s_barrier
    s_mov_b32 s54, 0
    s_add_u32 m0, s32, 0
    s_nop 0
    buffer_load_dwordx4 v76, s[16:19], s54 offen nt lds
    s_add_u32 m0, m0, 32
    s_nop 0
    buffer_load_dwordx4 v76, s[16:19], s54 offen offset:1024 nt lds
    s_mov_b32 s54, 8192
    s_add_u32 m0, s32, 8448
    s_nop 0
    buffer_load_dwordx4 v76, s[16:19], s54 offen nt lds
    s_add_u32 m0, m0, 32
    s_nop 0
    buffer_load_dwordx4 v76, s[16:19], s54 offen offset:1024 nt lds
    s_mov_b32 s54, 0
    s_add_u32 m0, s32, 16896
    s_nop 0
    buffer_load_dwordx4 v76, s[20:23], s54 offen nt lds
    s_add_u32 m0, m0, 32
    s_nop 0
    buffer_load_dwordx4 v76, s[20:23], s54 offen offset:1024 nt lds
    s_mov_b32 s54, 8192
    s_add_u32 m0, s32, 25344
    s_nop 0
    buffer_load_dwordx4 v76, s[20:23], s54 offen nt lds
    s_add_u32 m0, m0, 32
    s_nop 0
    buffer_load_dwordx4 v76, s[20:23], s54 offen offset:1024 nt lds
    s_mov_b32 s54, 16384
    s_add_u32 m0, s32, 33792
    s_nop 0
    buffer_load_dwordx4 v76, s[16:19], s54 offen nt lds
    s_add_u32 m0, m0, 32
    s_nop 0
    buffer_load_dwordx4 v76, s[16:19], s54 offen offset:1024 nt lds
    s_mov_b32 s40, 42240
    s_mov_b32 s41, 50688
    s_mov_b32 s42, 59136
    s_mov_b32 s43, 67584
    s_mov_b32 s38, 16384
    v_accvgpr_write_b32 a0, 0
    v_accvgpr_write_b32 a1, 0
    v_accvgpr_write_b32 a2, 0
    v_accvgpr_write_b32 a3, 0
    v_accvgpr_write_b32 a4, 0
    v_accvgpr_write_b32 a5, 0
    v_accvgpr_write_b32 a6, 0
    v_accvgpr_write_b32 a7, 0
    v_accvgpr_write_b32 a8, 0
    v_accvgpr_write_b32 a9, 0
    v_accvgpr_write_b32 a10, 0
    v_accvgpr_write_b32 a11, 0
    v_accvgpr_write_b32 a12, 0
    v_accvgpr_write_b32 a13, 0
    v_accvgpr_write_b32 a14, 0
    v_accvgpr_write_b32 a15, 0
    v_accvgpr_write_b32 a16, 0
    v_accvgpr_write_b32 a17, 0
    v_accvgpr_write_b32 a18, 0
    v_accvgpr_write_b32 a19, 0
    v_accvgpr_write_b32 a20, 0
    v_accvgpr_write_b32 a21, 0
    v_accvgpr_write_b32 a22, 0
    v_accvgpr_write_b32 a23, 0
    v_accvgpr_write_b32 a24, 0
    v_accvgpr_write_b32 a25, 0
    v_accvgpr_write_b32 a26, 0
    v_accvgpr_write_b32 a27, 0
    v_accvgpr_write_b32 a28, 0
    v_accvgpr_write_b32 a29, 0
    v_accvgpr_write_b32 a30, 0
    v_accvgpr_write_b32 a31, 0
    v_accvgpr_write_b32 a32, 0
    v_accvgpr_write_b32 a33, 0
    v_accvgpr_write_b32 a34, 0
    v_accvgpr_write_b32 a35, 0
    v_accvgpr_write_b32 a36, 0
    v_accvgpr_write_b32 a37, 0
    v_accvgpr_write_b32 a38, 0
    v_accvgpr_write_b32 a39, 0
    v_accvgpr_write_b32 a40, 0
    v_accvgpr_write_b32 a41, 0
    v_accvgpr_write_b32 a42, 0
    v_accvgpr_write_b32 a43, 0
    v_accvgpr_write_b32 a44, 0
    v_accvgpr_write_b32 a45, 0
    v_accvgpr_write_b32 a46, 0
    v_accvgpr_write_b32 a47, 0
    v_accvgpr_write_b32 a48, 0
    v_accvgpr_write_b32 a49, 0
    v_accvgpr_write_b32 a50, 0
    v_accvgpr_write_b32 a51, 0
    v_accvgpr_write_b32 a52, 0
    v_accvgpr_write_b32 a53, 0
    v_accvgpr_write_b32 a54, 0
    v_accvgpr_write_b32 a55, 0
    v_accvgpr_write_b32 a56, 0
    v_accvgpr_write_b32 a57, 0
    v_accvgpr_write_b32 a58, 0
    v_accvgpr_write_b32 a59, 0
    v_accvgpr_write_b32 a60, 0
    v_accvgpr_write_b32 a61, 0
    v_accvgpr_write_b32 a62, 0
    v_accvgpr_write_b32 a63, 0
    v_accvgpr_write_b32 a64, 0
    v_accvgpr_write_b32 a65, 0
    v_accvgpr_write_b32 a66, 0
    v_accvgpr_write_b32 a67, 0
    v_accvgpr_write_b32 a68, 0
    v_accvgpr_write_b32 a69, 0
    v_accvgpr_write_b32 a70, 0
    v_accvgpr_write_b32 a71, 0
    v_accvgpr_write_b32 a72, 0
    v_accvgpr_write_b32 a73, 0
    v_accvgpr_write_b32 a74, 0
    v_accvgpr_write_b32 a75, 0
    v_accvgpr_write_b32 a76, 0
    v_accvgpr_write_b32 a77, 0
    v_accvgpr_write_b32 a78, 0
    v_accvgpr_write_b32 a79, 0
    v_accvgpr_write_b32 a80, 0
    v_accvgpr_write_b32 a81, 0
    v_accvgpr_write_b32 a82, 0
    v_accvgpr_write_b32 a83, 0
    v_accvgpr_write_b32 a84, 0
    v_accvgpr_write_b32 a85, 0
    v_accvgpr_write_b32 a86, 0
    v_accvgpr_write_b32 a87, 0
    v_accvgpr_write_b32 a88, 0
    v_accvgpr_write_b32 a89, 0
    v_accvgpr_write_b32 a90, 0
    v_accvgpr_write_b32 a91, 0
    v_accvgpr_write_b32 a92, 0
    v_accvgpr_write_b32 a93, 0
    v_accvgpr_write_b32 a94, 0
    v_accvgpr_write_b32 a95, 0
    v_accvgpr_write_b32 a96, 0
    v_accvgpr_write_b32 a97, 0
    v_accvgpr_write_b32 a98, 0
    v_accvgpr_write_b32 a99, 0
    v_accvgpr_write_b32 a100, 0
    v_accvgpr_write_b32 a101, 0
    v_accvgpr_write_b32 a102, 0
    v_accvgpr_write_b32 a103, 0
    v_accvgpr_write_b32 a104, 0
    v_accvgpr_write_b32 a105, 0
    v_accvgpr_write_b32 a106, 0
    v_accvgpr_write_b32 a107, 0
    v_accvgpr_write_b32 a108, 0
    v_accvgpr_write_b32 a109, 0
    v_accvgpr_write_b32 a110, 0
    v_accvgpr_write_b32 a111, 0
    v_accvgpr_write_b32 a112, 0
    v_accvgpr_write_b32 a113, 0
    v_accvgpr_write_b32 a114, 0
    v_accvgpr_write_b32 a115, 0
    v_accvgpr_write_b32 a116, 0
    v_accvgpr_write_b32 a117, 0
    v_accvgpr_write_b32 a118, 0
    v_accvgpr_write_b32 a119, 0
    v_accvgpr_write_b32 a120, 0
    v_accvgpr_write_b32 a121, 0
    v_accvgpr_write_b32 a122, 0
    v_accvgpr_write_b32 a123, 0
    v_accvgpr_write_b32 a124, 0
    v_accvgpr_write_b32 a125, 0
    v_accvgpr_write_b32 a126, 0
    v_accvgpr_write_b32 a127, 0
    v_mov_b32 v68, 0
    v_mov_b32 v69, 0
    v_mov_b32 v70, 0
    v_mov_b32 v71, 0
    v_mov_b32 v42, 0xff61b1e6
    v_mov_b32 v43, 0xff61b1e6
    v_mov_b32 v78, 0xff61b1e6
    v_mov_b32 v79, 0xff61b1e6
    s_mov_b32 s37, 0
    s_nop 9
L_attn_safe:
    s_waitcnt vmcnt(2)
    s_barrier
    s_mov_b32 s44, s40
    s_mov_b32 s45, s41
    s_mov_b32 s46, s42
    s_mov_b32 s47, s43
    s_add_u32 s40, s47, 8448
    s_cmp_eq_u32 s40, 76032
    s_cselect_b32 s40, 0, s40
    s_add_u32 s41, s40, 8448
    s_cmp_eq_u32 s41, 76032
    s_cselect_b32 s41, 0, s41
    s_add_u32 s42, s41, 8448
    s_cmp_eq_u32 s42, 76032
    s_cselect_b32 s42, 0, s42
    s_add_u32 s43, s42, 8448
    s_cmp_eq_u32 s43, 76032
    s_cselect_b32 s43, 0, s43
    s_cmp_eq_u32 s30, 0
    s_cselect_b32 s48, s40, s41
    s_cselect_b32 s49, s41, s40
    s_cselect_b32 s50, s42, s43
    s_cselect_b32 s51, s43, s42
    s_sub_u32 s60, s48, s52
    s_mov_b32 s52, s48
    v_add_u32 v72, s60, v72
    v_add_u32 v73, s60, v73
    ds_read_b128 v[44:47], v72 offset:0
    ds_read_b128 v[60:63], v77 offset:0
    ds_read_b128 v[48:51], v72 offset:256
    ds_read_b128 v[64:67], v77 offset:1024
    ds_read_b128 v[52:55], v72 offset:512
    s_add_u32 s54, s38, 8192
    s_add_u32 s55, s38, 16384
    ds_read_b128 v[56:59], v72 offset:768
    s_waitcnt lgkmcnt(5)
    v_mfma_f32_16x16x32_bf16 v[0:3], v[44:47], a[128:131], 0
    v_mfma_f32_16x16x32_bf16 v[8:11], v[44:47], a[144:147], 0
    v_mfma_f32_16x16x32_bf16 v[16:19], v[44:47], a[160:163], 0
    s_waitcnt lgkmcnt(4)
    v_mfma_f32_16x16x32_bf16 v[24:27], v[44:47], v[60:63], 0
    ds_read_b128 v[60:63], v77 offset:2048
    ds_read_b128 v[44:47], v73 offset:0
    s_waitcnt lgkmcnt(5)
    v_mfma_f32_16x16x32_bf16 v[0:3], v[48:51], a[132:135], v[0:3]
    v_mfma_f32_16x16x32_bf16 v[8:11], v[48:51], a[148:151], v[8:11]
    v_mfma_f32_16x16x32_bf16 v[16:19], v[48:51], a[164:167], v[16:19]
    s_waitcnt lgkmcnt(4)
    v_mfma_f32_16x16x32_bf16 v[24:27], v[48:51], v[64:67], v[24:27]
    ds_read_b128 v[64:67], v77 offset:3072
    ds_read_b128 v[48:51], v73 offset:256
    s_waitcnt lgkmcnt(5)
    v_mfma_f32_16x16x32_bf16 v[0:3], v[52:55], a[136:139], v[0:3]
    v_mfma_f32_16x16x32_bf16 v[8:11], v[52:55], a[152:155], v[8:11]
    v_mfma_f32_16x16x32_bf16 v[16:19], v[52:55], a[168:171], v[16:19]
    s_waitcnt lgkmcnt(3)
    v_mfma_f32_16x16x32_bf16 v[24:27], v[52:55], v[60:63], v[24:27]
    s_add_u32 m0, s32, s44
    s_nop 0
    buffer_load_dwordx4 v76, s[16:19], s54 offen nt lds
    s_add_u32 m0, m0, 32
    s_nop 0
    buffer_load_dwordx4 v76, s[16:19], s54 offen offset:1024 nt lds
    ds_read_b128 v[52:55], v73 offset:512
    v_mfma_f32_16x16x32_bf16 v[0:3], v[56:59], a[140:143], v[0:3]
    v_mfma_f32_16x16x32_bf16 v[8:11], v[56:59], a[156:159], v[8:11]
    v_mfma_f32_16x16x32_bf16 v[16:19], v[56:59], a[172:175], v[16:19]
    s_waitcnt lgkmcnt(2)
    v_mfma_f32_16x16x32_bf16 v[24:27], v[56:59], v[64:67], v[24:27]
    ds_read_b128 v[56:59], v73 offset:768
    s_sub_u32 s60, s49, s52
    s_mov_b32 s52, s49
    v_add_u32 v72, s60, v72
    v_add_u32 v73, s60, v73
    v_mfma_f32_16x16x32_bf16 v[4:7], v[44:47], a[128:131], 0
    v_mfma_f32_16x16x32_bf16 v[12:15], v[44:47], a[144:147], 0
    v_mfma_f32_16x16x32_bf16 v[20:23], v[44:47], a[160:163], 0
    s_sub_u32 s61, s50, s53
    s_mov_b32 s53, s50
    v_add_u32 v74, s61, v74
    v_add_u32 v75, s61, v75
    ds_read_b64_tr_b16 v[44:45], v74 offset:0
    ds_read_b64_tr_b16 v[46:47], v75 offset:0
    s_waitcnt lgkmcnt(4)
    v_mfma_f32_16x16x32_bf16 v[4:7], v[48:51], a[132:135], v[4:7]
    v_mfma_f32_16x16x32_bf16 v[12:15], v[48:51], a[148:151], v[12:15]
    v_mfma_f32_16x16x32_bf16 v[20:23], v[48:51], a[164:167], v[20:23]
    ds_read_b64_tr_b16 v[48:49], v74 offset:32
    ds_read_b64_tr_b16 v[50:51], v75 offset:32
    s_waitcnt lgkmcnt(5)
    v_mfma_f32_16x16x32_bf16 v[4:7], v[52:55], a[136:139], v[4:7]
    v_mfma_f32_16x16x32_bf16 v[12:15], v[52:55], a[152:155], v[12:15]
    v_mfma_f32_16x16x32_bf16 v[20:23], v[52:55], a[168:171], v[20:23]
    ds_read_b64_tr_b16 v[52:53], v74 offset:256
    ds_read_b64_tr_b16 v[54:55], v75 offset:256
    s_waitcnt lgkmcnt(6)
    v_mfma_f32_16x16x32_bf16 v[4:7], v[56:59], a[140:143], v[4:7]
    v_mfma_f32_16x16x32_bf16 v[12:15], v[56:59], a[156:159], v[12:15]
    v_mfma_f32_16x16x32_bf16 v[20:23], v[56:59], a[172:175], v[20:23]
    s_add_u32 m0, s32, s45
    s_nop 0
    buffer_load_dwordx4 v76, s[20:23], s38 offen nt lds
    s_add_u32 m0, m0, 32
    s_nop 0
    buffer_load_dwordx4 v76, s[20:23], s38 offen offset:1024 nt lds
    ds_read_b64_tr_b16 v[56:57], v74 offset:288
    ds_read_b64_tr_b16 v[58:59], v75 offset:288
    v_max3_f32 v28, v0, v1, v2
    v_max_f32 v28, v28, v3
    v_max3_f32 v28, v28, v4, v5
    v_max3_f32 v28, v28, v6, v7
    v_mov_b32 v29, v28
    s_nop 1
    v_permlane32_swap_b32 v28, v29
    v_max_f32 v28, v28, v29
    v_mov_b32 v29, v28
    s_nop 1
    v_permlane16_swap_b32 v28, v29
    v_max_f32 v28, v28, v29
    v_max_f32 v28, v28, v42
    v_sub_f32 v29, v42, v28
    v_exp_f32 v29, v29
    v_mov_b32 v42, v28
    v_mul_f32 v68, v68, v29
    v_sub_f32 v0, v0, v28
    v_sub_f32 v1, v1, v28
    v_sub_f32 v2, v2, v28
    v_sub_f32 v3, v3, v28
    v_sub_f32 v4, v4, v28
    v_sub_f32 v5, v5, v28
    v_sub_f32 v6, v6, v28
    v_sub_f32 v7, v7, v28
    v_accvgpr_read_b32 v28, a0
    v_mul_f32 v28, v28, v29
    v_accvgpr_write_b32 a0, v28
    v_accvgpr_read_b32 v28, a1
    v_mul_f32 v28, v28, v29
    v_accvgpr_write_b32 a1, v28
    v_accvgpr_read_b32 v28, a2
    v_mul_f32 v28, v28, v29
    v_accvgpr_write_b32 a2, v28
    v_accvgpr_read_b32 v28, a3
    v_mul_f32 v28, v28, v29
    v_accvgpr_write_b32 a3, v28
    v_accvgpr_read_b32 v28, a4
    v_mul_f32 v28, v28, v29
    v_accvgpr_write_b32 a4, v28
    v_accvgpr_read_b32 v28, a5
    v_mul_f32 v28, v28, v29
    v_accvgpr_write_b32 a5, v28
    v_accvgpr_read_b32 v28, a6
    v_mul_f32 v28, v28, v29
    v_accvgpr_write_b32 a6, v28
    v_accvgpr_read_b32 v28, a7
    v_mul_f32 v28, v28, v29
    v_accvgpr_write_b32 a7, v28
    v_accvgpr_read_b32 v28, a8
    v_mul_f32 v28, v28, v29
    v_accvgpr_write_b32 a8, v28
    v_accvgpr_read_b32 v28, a9
    v_mul_f32 v28, v28, v29
    v_accvgpr_write_b32 a9, v28
    v_accvgpr_read_b32 v28, a10
    v_mul_f32 v28, v28, v29
    v_accvgpr_write_b32 a10, v28
    v_accvgpr_read_b32 v28, a11
    v_mul_f32 v28, v28, v29
    v_accvgpr_write_b32 a11, v28
    v_accvgpr_read_b32 v28, a12
    v_mul_f32 v28, v28, v29
    v_accvgpr_write_b32 a12, v28
    v_accvgpr_read_b32 v28, a13
    v_mul_f32 v28, v28, v29
    v_accvgpr_write_b32 a13, v28
    v_accvgpr_read_b32 v28, a14
    v_mul_f32 v28, v28, v29
    v_accvgpr_write_b32 a14, v28
    v_accvgpr_read_b32 v28, a15
    v_mul_f32 v28, v28, v29
    v_accvgpr_write_b32 a15, v28
    v_accvgpr_read_b32 v28, a16
    v_mul_f32 v28, v28, v29
    v_accvgpr_write_b32 a16, v28
    v_accvgpr_read_b32 v28, a17
    v_mul_f32 v28, v28, v29
    v_accvgpr_write_b32 a17, v28
    v_accvgpr_read_b32 v28, a18
    v_mul_f32 v28, v28, v29
    v_accvgpr_write_b32 a18, v28
    v_accvgpr_read_b32 v28, a19
    v_mul_f32 v28, v28, v29
    v_accvgpr_write_b32 a19, v28
    v_accvgpr_read_b32 v28, a20
    v_mul_f32 v28, v28, v29
    v_accvgpr_write_b32 a20, v28
    v_accvgpr_read_b32 v28, a21
    v_mul_f32 v28, v28, v29
    v_accvgpr_write_b32 a21, v28
    v_accvgpr_read_b32 v28, a22
    v_mul_f32 v28, v28, v29
    v_accvgpr_write_b32 a22, v28
    v_accvgpr_read_b32 v28, a23
    v_mul_f32 v28, v28, v29
    v_accvgpr_write_b32 a23, v28
    v_accvgpr_read_b32 v28, a24
    v_mul_f32 v28, v28, v29
    v_accvgpr_write_b32 a24, v28
    v_accvgpr_read_b32 v28, a25
    v_mul_f32 v28, v28, v29
    v_accvgpr_write_b32 a25, v28
    v_accvgpr_read_b32 v28, a26
    v_mul_f32 v28, v28, v29
    v_accvgpr_write_b32 a26, v28
    v_accvgpr_read_b32 v28, a27
    v_mul_f32 v28, v28, v29
    v_accvgpr_write_b32 a27, v28
    v_accvgpr_read_b32 v28, a28
    v_mul_f32 v28, v28, v29
    v_accvgpr_write_b32 a28, v28
    v_accvgpr_read_b32 v28, a29
    v_mul_f32 v28, v28, v29
    v_accvgpr_write_b32 a29, v28
    v_accvgpr_read_b32 v28, a30
    v_mul_f32 v28, v28, v29
    v_accvgpr_write_b32 a30, v28
    v_accvgpr_read_b32 v28, a31
    v_mul_f32 v28, v28, v29
    v_accvgpr_write_b32 a31, v28
    v_max3_f32 v32, v8, v9, v10
    v_max_f32 v32, v32, v11
    v_max3_f32 v32, v32, v12, v13
    v_max3_f32 v32, v32, v14, v15
    v_mov_b32 v33, v32
    s_nop 1
    v_permlane32_swap_b32 v32, v33
    v_max_f32 v32, v32, v33
    v_mov_b32 v33, v32
    s_nop 1
    v_permlane16_swap_b32 v32, v33
    v_max_f32 v32, v32, v33
    v_max_f32 v32, v32, v43
    v_sub_f32 v33, v43, v32
    v_exp_f32 v33, v33
    v_mov_b32 v43, v32
    v_mul_f32 v69, v69, v33
    v_sub_f32 v8, v8, v32
    v_sub_f32 v9, v9, v32
    v_sub_f32 v10, v10, v32
    v_sub_f32 v11, v11, v32
    v_sub_f32 v12, v12, v32
    v_sub_f32 v13, v13, v32
    v_sub_f32 v14, v14, v32
    v_sub_f32 v15, v15, v32
    v_accvgpr_read_b32 v32, a32
    v_mul_f32 v32, v32, v33
    v_accvgpr_write_b32 a32, v32
    v_accvgpr_read_b32 v32, a33
    v_mul_f32 v32, v32, v33
    v_accvgpr_write_b32 a33, v32
    v_accvgpr_read_b32 v32, a34
    v_mul_f32 v32, v32, v33
    v_accvgpr_write_b32 a34, v32
    v_accvgpr_read_b32 v32, a35
    v_mul_f32 v32, v32, v33
    v_accvgpr_write_b32 a35, v32
    v_accvgpr_read_b32 v32, a36
    v_mul_f32 v32, v32, v33
    v_accvgpr_write_b32 a36, v32
    v_accvgpr_read_b32 v32, a37
    v_mul_f32 v32, v32, v33
    v_accvgpr_write_b32 a37, v32
    v_accvgpr_read_b32 v32, a38
    v_mul_f32 v32, v32, v33
    v_accvgpr_write_b32 a38, v32
    v_accvgpr_read_b32 v32, a39
    v_mul_f32 v32, v32, v33
    v_accvgpr_write_b32 a39, v32
    v_accvgpr_read_b32 v32, a40
    v_mul_f32 v32, v32, v33
    v_accvgpr_write_b32 a40, v32
    v_accvgpr_read_b32 v32, a41
    v_mul_f32 v32, v32, v33
    v_accvgpr_write_b32 a41, v32
    v_accvgpr_read_b32 v32, a42
    v_mul_f32 v32, v32, v33
    v_accvgpr_write_b32 a42, v32
    v_accvgpr_read_b32 v32, a43
    v_mul_f32 v32, v32, v33
    v_accvgpr_write_b32 a43, v32
    v_accvgpr_read_b32 v32, a44
    v_mul_f32 v32, v32, v33
    v_accvgpr_write_b32 a44, v32
    v_accvgpr_read_b32 v32, a45
    v_mul_f32 v32, v32, v33
    v_accvgpr_write_b32 a45, v32
    v_accvgpr_read_b32 v32, a46
    v_mul_f32 v32, v32, v33
    v_accvgpr_write_b32 a46, v32
    v_accvgpr_read_b32 v32, a47
    v_mul_f32 v32, v32, v33
    v_accvgpr_write_b32 a47, v32
    v_accvgpr_read_b32 v32, a48
    v_mul_f32 v32, v32, v33
    v_accvgpr_write_b32 a48, v32
    v_accvgpr_read_b32 v32, a49
    v_mul_f32 v32, v32, v33
    v_accvgpr_write_b32 a49, v32
    v_accvgpr_read_b32 v32, a50
    v_mul_f32 v32, v32, v33
    v_accvgpr_write_b32 a50, v32
    v_accvgpr_read_b32 v32, a51
    v_mul_f32 v32, v32, v33
    v_accvgpr_write_b32 a51, v32
    v_accvgpr_read_b32 v32, a52
    v_mul_f32 v32, v32, v33
    v_accvgpr_write_b32 a52, v32
    v_accvgpr_read_b32 v32, a53
    v_mul_f32 v32, v32, v33
    v_accvgpr_write_b32 a53, v32
    v_accvgpr_read_b32 v32, a54
    v_mul_f32 v32, v32, v33
    v_accvgpr_write_b32 a54, v32
    v_accvgpr_read_b32 v32, a55
    v_mul_f32 v32, v32, v33
    v_accvgpr_write_b32 a55, v32
    v_accvgpr_read_b32 v32, a56
    v_mul_f32 v32, v32, v33
    v_accvgpr_write_b32 a56, v32
    v_accvgpr_read_b32 v32, a57
    v_mul_f32 v32, v32, v33
    v_accvgpr_write_b32 a57, v32
    v_accvgpr_read_b32 v32, a58
    v_mul_f32 v32, v32, v33
    v_accvgpr_write_b32 a58, v32
    v_accvgpr_read_b32 v32, a59
    v_mul_f32 v32, v32, v33
    v_accvgpr_write_b32 a59, v32
    v_accvgpr_read_b32 v32, a60
    v_mul_f32 v32, v32, v33
    v_accvgpr_write_b32 a60, v32
    v_accvgpr_read_b32 v32, a61
    v_mul_f32 v32, v32, v33
    v_accvgpr_write_b32 a61, v32
    v_accvgpr_read_b32 v32, a62
    v_mul_f32 v32, v32, v33
    v_accvgpr_write_b32 a62, v32
    v_accvgpr_read_b32 v32, a63
    v_mul_f32 v32, v32, v33
    v_accvgpr_write_b32 a63, v32
    v_max3_f32 v36, v16, v17, v18
    v_max_f32 v36, v36, v19
    v_max3_f32 v36, v36, v20, v21
    v_max3_f32 v36, v36, v22, v23
    v_mov_b32 v37, v36
    s_nop 1
    v_permlane32_swap_b32 v36, v37
    v_max_f32 v36, v36, v37
    v_mov_b32 v37, v36
    s_nop 1
    v_permlane16_swap_b32 v36, v37
    v_max_f32 v36, v36, v37
    v_max_f32 v36, v36, v78
    v_sub_f32 v37, v78, v36
    v_exp_f32 v37, v37
    v_mov_b32 v78, v36
    v_mul_f32 v70, v70, v37
    v_sub_f32 v16, v16, v36
    v_sub_f32 v17, v17, v36
    v_sub_f32 v18, v18, v36
    v_sub_f32 v19, v19, v36
    v_sub_f32 v20, v20, v36
    v_sub_f32 v21, v21, v36
    v_sub_f32 v22, v22, v36
    v_sub_f32 v23, v23, v36
    v_accvgpr_read_b32 v36, a64
    v_mul_f32 v36, v36, v37
    v_accvgpr_write_b32 a64, v36
    v_accvgpr_read_b32 v36, a65
    v_mul_f32 v36, v36, v37
    v_accvgpr_write_b32 a65, v36
    v_accvgpr_read_b32 v36, a66
    v_mul_f32 v36, v36, v37
    v_accvgpr_write_b32 a66, v36
    v_accvgpr_read_b32 v36, a67
    v_mul_f32 v36, v36, v37
    v_accvgpr_write_b32 a67, v36
    v_accvgpr_read_b32 v36, a68
    v_mul_f32 v36, v36, v37
    v_accvgpr_write_b32 a68, v36
    v_accvgpr_read_b32 v36, a69
    v_mul_f32 v36, v36, v37
    v_accvgpr_write_b32 a69, v36
    v_accvgpr_read_b32 v36, a70
    v_mul_f32 v36, v36, v37
    v_accvgpr_write_b32 a70, v36
    v_accvgpr_read_b32 v36, a71
    v_mul_f32 v36, v36, v37
    v_accvgpr_write_b32 a71, v36
    v_accvgpr_read_b32 v36, a72
    v_mul_f32 v36, v36, v37
    v_accvgpr_write_b32 a72, v36
    v_accvgpr_read_b32 v36, a73
    v_mul_f32 v36, v36, v37
    v_accvgpr_write_b32 a73, v36
    v_accvgpr_read_b32 v36, a74
    v_mul_f32 v36, v36, v37
    v_accvgpr_write_b32 a74, v36
    v_accvgpr_read_b32 v36, a75
    v_mul_f32 v36, v36, v37
    v_accvgpr_write_b32 a75, v36
    v_accvgpr_read_b32 v36, a76
    v_mul_f32 v36, v36, v37
    v_accvgpr_write_b32 a76, v36
    v_accvgpr_read_b32 v36, a77
    v_mul_f32 v36, v36, v37
    v_accvgpr_write_b32 a77, v36
    v_accvgpr_read_b32 v36, a78
    v_mul_f32 v36, v36, v37
    v_accvgpr_write_b32 a78, v36
    v_accvgpr_read_b32 v36, a79
    v_mul_f32 v36, v36, v37
    v_accvgpr_write_b32 a79, v36
    v_accvgpr_read_b32 v36, a80
    v_mul_f32 v36, v36, v37
    v_accvgpr_write_b32 a80, v36
    v_accvgpr_read_b32 v36, a81
    v_mul_f32 v36, v36, v37
    v_accvgpr_write_b32 a81, v36
    v_accvgpr_read_b32 v36, a82
    v_mul_f32 v36, v36, v37
    v_accvgpr_write_b32 a82, v36
    v_accvgpr_read_b32 v36, a83
    v_mul_f32 v36, v36, v37
    v_accvgpr_write_b32 a83, v36
    v_accvgpr_read_b32 v36, a84
    v_mul_f32 v36, v36, v37
    v_accvgpr_write_b32 a84, v36
    v_accvgpr_read_b32 v36, a85
    v_mul_f32 v36, v36, v37
    v_accvgpr_write_b32 a85, v36
    v_accvgpr_read_b32 v36, a86
    v_mul_f32 v36, v36, v37
    v_accvgpr_write_b32 a86, v36
    v_accvgpr_read_b32 v36, a87
    v_mul_f32 v36, v36, v37
    v_accvgpr_write_b32 a87, v36
    v_accvgpr_read_b32 v36, a88
    v_mul_f32 v36, v36, v37
    v_accvgpr_write_b32 a88, v36
    v_accvgpr_read_b32 v36, a89
    v_mul_f32 v36, v36, v37
    v_accvgpr_write_b32 a89, v36
    v_accvgpr_read_b32 v36, a90
    v_mul_f32 v36, v36, v37
    v_accvgpr_write_b32 a90, v36
    v_accvgpr_read_b32 v36, a91
    v_mul_f32 v36, v36, v37
    v_accvgpr_write_b32 a91, v36
    v_accvgpr_read_b32 v36, a92
    v_mul_f32 v36, v36, v37
    v_accvgpr_write_b32 a92, v36
    v_accvgpr_read_b32 v36, a93
    v_mul_f32 v36, v36, v37
    v_accvgpr_write_b32 a93, v36
    v_accvgpr_read_b32 v36, a94
    v_mul_f32 v36, v36, v37
    v_accvgpr_write_b32 a94, v36
    v_accvgpr_read_b32 v36, a95
    v_mul_f32 v36, v36, v37
    v_accvgpr_write_b32 a95, v36
    v_max3_f32 v40, v24, v25, v26
    v_max_f32 v40, v40, v27
    v_mov_b32 v41, v40
    s_nop 1
    v_permlane32_swap_b32 v40, v41
    v_max_f32 v40, v40, v41
    v_mov_b32 v41, v40
    s_nop 1
    v_permlane16_swap_b32 v40, v41
    v_max_f32 v40, v40, v41
    v_max_f32 v40, v40, v79
    v_sub_f32 v41, v79, v40
    v_exp_f32 v41, v41
    v_mov_b32 v79, v40
    v_mul_f32 v71, v71, v41
    v_sub_f32 v24, v24, v40
    v_sub_f32 v25, v25, v40
    v_sub_f32 v26, v26, v40
    v_sub_f32 v27, v27, v40
    v_accvgpr_read_b32 v40, a96
    v_mul_f32 v40, v40, v41
    v_accvgpr_write_b32 a96, v40
    v_accvgpr_read_b32 v40, a97
    v_mul_f32 v40, v40, v41
    v_accvgpr_write_b32 a97, v40
    v_accvgpr_read_b32 v40, a98
    v_mul_f32 v40, v40, v41
    v_accvgpr_write_b32 a98, v40
    v_accvgpr_read_b32 v40, a99
    v_mul_f32 v40, v40, v41
    v_accvgpr_write_b32 a99, v40
    v_accvgpr_read_b32 v40, a100
    v_mul_f32 v40, v40, v41
    v_accvgpr_write_b32 a100, v40
    v_accvgpr_read_b32 v40, a101
    v_mul_f32 v40, v40, v41
    v_accvgpr_write_b32 a101, v40
    v_accvgpr_read_b32 v40, a102
    v_mul_f32 v40, v40, v41
    v_accvgpr_write_b32 a102, v40
    v_accvgpr_read_b32 v40, a103
    v_mul_f32 v40, v40, v41
    v_accvgpr_write_b32 a103, v40
    v_accvgpr_read_b32 v40, a104
    v_mul_f32 v40, v40, v41
    v_accvgpr_write_b32 a104, v40
    v_accvgpr_read_b32 v40, a105
    v_mul_f32 v40, v40, v41
    v_accvgpr_write_b32 a105, v40
    v_accvgpr_read_b32 v40, a106
    v_mul_f32 v40, v40, v41
    v_accvgpr_write_b32 a106, v40
    v_accvgpr_read_b32 v40, a107
    v_mul_f32 v40, v40, v41
    v_accvgpr_write_b32 a107, v40
    v_accvgpr_read_b32 v40, a108
    v_mul_f32 v40, v40, v41
    v_accvgpr_write_b32 a108, v40
    v_accvgpr_read_b32 v40, a109
    v_mul_f32 v40, v40, v41
    v_accvgpr_write_b32 a109, v40
    v_accvgpr_read_b32 v40, a110
    v_mul_f32 v40, v40, v41
    v_accvgpr_write_b32 a110, v40
    v_accvgpr_read_b32 v40, a111
    v_mul_f32 v40, v40, v41
    v_accvgpr_write_b32 a111, v40
    v_accvgpr_read_b32 v40, a112
    v_mul_f32 v40, v40, v41
    v_accvgpr_write_b32 a112, v40
    v_accvgpr_read_b32 v40, a113
    v_mul_f32 v40, v40, v41
    v_accvgpr_write_b32 a113, v40
    v_accvgpr_read_b32 v40, a114
    v_mul_f32 v40, v40, v41
    v_accvgpr_write_b32 a114, v40
    v_accvgpr_read_b32 v40, a115
    v_mul_f32 v40, v40, v41
    v_accvgpr_write_b32 a115, v40
    v_accvgpr_read_b32 v40, a116
    v_mul_f32 v40, v40, v41
    v_accvgpr_write_b32 a116, v40
    v_accvgpr_read_b32 v40, a117
    v_mul_f32 v40, v40, v41
    v_accvgpr_write_b32 a117, v40
    v_accvgpr_read_b32 v40, a118
    v_mul_f32 v40, v40, v41
    v_accvgpr_write_b32 a118, v40
    v_accvgpr_read_b32 v40, a119
    v_mul_f32 v40, v40, v41
    v_accvgpr_write_b32 a119, v40
    v_accvgpr_read_b32 v40, a120
    v_mul_f32 v40, v40, v41
    v_accvgpr_write_b32 a120, v40
    v_accvgpr_read_b32 v40, a121
    v_mul_f32 v40, v40, v41
    v_accvgpr_write_b32 a121, v40
    v_accvgpr_read_b32 v40, a122
    v_mul_f32 v40, v40, v41
    v_accvgpr_write_b32 a122, v40
    v_accvgpr_read_b32 v40, a123
    v_mul_f32 v40, v40, v41
    v_accvgpr_write_b32 a123, v40
    v_accvgpr_read_b32 v40, a124
    v_mul_f32 v40, v40, v41
    v_accvgpr_write_b32 a124, v40
    v_accvgpr_read_b32 v40, a125
    v_mul_f32 v40, v40, v41
    v_accvgpr_write_b32 a125, v40
    v_accvgpr_read_b32 v40, a126
    v_mul_f32 v40, v40, v41
    v_accvgpr_write_b32 a126, v40
    v_accvgpr_read_b32 v40, a127
    v_mul_f32 v40, v40, v41
    v_accvgpr_write_b32 a127, v40
    v_exp_f32 v0, v0
    v_exp_f32 v1, v1
    v_exp_f32 v2, v2
    v_exp_f32 v3, v3
    v_cvt_pk_bf16_f32 v28, v0, v1
    v_cvt_pk_bf16_f32 v29, v2, v3
    v_exp_f32 v4, v4
    v_exp_f32 v5, v5
    v_exp_f32 v6, v6
    v_exp_f32 v7, v7
    v_cvt_pk_bf16_f32 v30, v4, v5
    v_cvt_pk_bf16_f32 v31, v6, v7
    v_exp_f32 v8, v8
    v_exp_f32 v9, v9
    v_exp_f32 v10, v10
    v_exp_f32 v11, v11
    v_cvt_pk_bf16_f32 v32, v8, v9
    v_cvt_pk_bf16_f32 v33, v10, v11
    v_exp_f32 v12, v12
    v_exp_f32 v13, v13
    v_exp_f32 v14, v14
    v_exp_f32 v15, v15
    v_cvt_pk_bf16_f32 v34, v12, v13
    v_cvt_pk_bf16_f32 v35, v14, v15
    v_exp_f32 v16, v16
    v_exp_f32 v17, v17
    v_exp_f32 v18, v18
    v_exp_f32 v19, v19
    v_cvt_pk_bf16_f32 v36, v16, v17
    v_cvt_pk_bf16_f32 v37, v18, v19
    v_exp_f32 v20, v20
    v_exp_f32 v21, v21
    v_exp_f32 v22, v22
    v_exp_f32 v23, v23
    v_cvt_pk_bf16_f32 v38, v20, v21
    v_cvt_pk_bf16_f32 v39, v22, v23
    v_exp_f32 v24, v24
    v_exp_f32 v25, v25
    v_exp_f32 v26, v26
    v_exp_f32 v27, v27
    v_cvt_pk_bf16_f32 v40, v24, v25
    v_cvt_pk_bf16_f32 v41, v26, v27
    s_waitcnt lgkmcnt(6)
    v_mfma_f32_16x16x32_bf16 a[0:3], v[44:47], v[28:31], a[0:3]
    v_add_f32 v68, v68, v0
    v_mfma_f32_16x16x32_bf16 a[32:35], v[44:47], v[32:35], a[32:35]
    v_add_f32 v68, v68, v1
    v_mfma_f32_16x16x32_bf16 a[64:67], v[44:47], v[36:39], a[64:67]
    v_add_f32 v68, v68, v2
    v_mfma_f32_16x16x16_bf16 a[96:99], v[44:45], v[40:41], a[96:99]
    v_add_f32 v68, v68, v3
    ds_read_b64_tr_b16 v[44:45], v74 offset:512
    ds_read_b64_tr_b16 v[46:47], v75 offset:512
    s_waitcnt lgkmcnt(6)
    v_mfma_f32_16x16x32_bf16 a[4:7], v[48:51], v[28:31], a[4:7]
    v_add_f32 v69, v69, v8
    v_mfma_f32_16x16x32_bf16 a[36:39], v[48:51], v[32:35], a[36:39]
    v_add_f32 v69, v69, v9
    v_mfma_f32_16x16x32_bf16 a[68:71], v[48:51], v[36:39], a[68:71]
    v_add_f32 v69, v69, v10
    v_mfma_f32_16x16x16_bf16 a[100:103], v[48:49], v[40:41], a[100:103]
    v_add_f32 v69, v69, v11
    ds_read_b64_tr_b16 v[48:49], v74 offset:544
    ds_read_b64_tr_b16 v[50:51], v75 offset:544
    s_waitcnt lgkmcnt(6)
    v_mfma_f32_16x16x32_bf16 a[8:11], v[52:55], v[28:31], a[8:11]
    v_add_f32 v70, v70, v16
    v_mfma_f32_16x16x32_bf16 a[40:43], v[52:55], v[32:35], a[40:43]
    v_add_f32 v70, v70, v17
    v_mfma_f32_16x16x32_bf16 a[72:75], v[52:55], v[36:39], a[72:75]
    v_add_f32 v70, v70, v18
    v_mfma_f32_16x16x16_bf16 a[104:107], v[52:53], v[40:41], a[104:107]
    v_add_f32 v70, v70, v19
    ds_read_b64_tr_b16 v[52:53], v74 offset:768
    ds_read_b64_tr_b16 v[54:55], v75 offset:768
    s_waitcnt lgkmcnt(6)
    v_mfma_f32_16x16x32_bf16 a[12:15], v[56:59], v[28:31], a[12:15]
    v_add_f32 v71, v71, v24
    v_mfma_f32_16x16x32_bf16 a[44:47], v[56:59], v[32:35], a[44:47]
    v_add_f32 v71, v71, v25
    v_mfma_f32_16x16x32_bf16 a[76:79], v[56:59], v[36:39], a[76:79]
    v_add_f32 v71, v71, v26
    v_mfma_f32_16x16x16_bf16 a[108:111], v[56:57], v[40:41], a[108:111]
    v_add_f32 v71, v71, v27
    ds_read_b64_tr_b16 v[56:57], v74 offset:800
    ds_read_b64_tr_b16 v[58:59], v75 offset:800
    s_waitcnt lgkmcnt(6)
    v_mfma_f32_16x16x32_bf16 a[16:19], v[44:47], v[28:31], a[16:19]
    v_add_f32 v68, v68, v4
    v_mfma_f32_16x16x32_bf16 a[48:51], v[44:47], v[32:35], a[48:51]
    v_add_f32 v68, v68, v5
    v_mfma_f32_16x16x32_bf16 a[80:83], v[44:47], v[36:39], a[80:83]
    v_add_f32 v68, v68, v6
    v_mfma_f32_16x16x16_bf16 a[112:115], v[44:45], v[40:41], a[112:115]
    v_add_f32 v68, v68, v7
    s_add_u32 m0, s32, s46
    s_nop 0
    buffer_load_dwordx4 v76, s[20:23], s54 offen nt lds
    s_add_u32 m0, m0, 32
    s_nop 0
    buffer_load_dwordx4 v76, s[20:23], s54 offen offset:1024 nt lds
    ds_read_b128 v[44:47], v72 offset:0
    s_waitcnt lgkmcnt(5)
    v_mfma_f32_16x16x32_bf16 a[20:23], v[48:51], v[28:31], a[20:23]
    v_add_f32 v69, v69, v12
    v_mfma_f32_16x16x32_bf16 a[52:55], v[48:51], v[32:35], a[52:55]
    v_add_f32 v69, v69, v13
    v_mfma_f32_16x16x32_bf16 a[84:87], v[48:51], v[36:39], a[84:87]
    v_add_f32 v69, v69, v14
    v_mfma_f32_16x16x16_bf16 a[116:119], v[48:49], v[40:41], a[116:119]
    v_add_f32 v69, v69, v15
    ds_read_b128 v[48:51], v72 offset:256
    s_waitcnt lgkmcnt(4)
    v_mfma_f32_16x16x32_bf16 a[24:27], v[52:55], v[28:31], a[24:27]
    v_add_f32 v70, v70, v20
    v_mfma_f32_16x16x32_bf16 a[56:59], v[52:55], v[32:35], a[56:59]
    v_add_f32 v70, v70, v21
    v_mfma_f32_16x16x32_bf16 a[88:91], v[52:55], v[36:39], a[88:91]
    v_add_f32 v70, v70, v22
    v_mfma_f32_16x16x16_bf16 a[120:123], v[52:53], v[40:41], a[120:123]
    v_add_f32 v70, v70, v23
    ds_read_b128 v[52:55], v72 offset:512
    s_waitcnt lgkmcnt(3)
    v_mfma_f32_16x16x32_bf16 a[28:31], v[56:59], v[28:31], a[28:31]
    v_mfma_f32_16x16x32_bf16 a[60:63], v[56:59], v[32:35], a[60:63]
    v_mfma_f32_16x16x32_bf16 a[92:95], v[56:59], v[36:39], a[92:95]
    v_mfma_f32_16x16x16_bf16 a[124:127], v[56:57], v[40:41], a[124:127]
    ds_read_b128 v[56:59], v72 offset:768
    s_waitcnt lgkmcnt(3)
    v_mfma_f32_16x16x32_bf16 v[0:3], v[44:47], a[128:131], 0
    v_mfma_f32_16x16x32_bf16 v[8:11], v[44:47], a[144:147], 0
    v_mfma_f32_16x16x32_bf16 v[16:19], v[44:47], a[160:163], 0
    ds_read_b128 v[44:47], v73 offset:0
    s_waitcnt lgkmcnt(3)
    v_mfma_f32_16x16x32_bf16 v[0:3], v[48:51], a[132:135], v[0:3]
    v_mfma_f32_16x16x32_bf16 v[8:11], v[48:51], a[148:151], v[8:11]
    v_mfma_f32_16x16x32_bf16 v[16:19], v[48:51], a[164:167], v[16:19]
    ds_read_b128 v[48:51], v73 offset:256
    s_waitcnt lgkmcnt(3)
    v_mfma_f32_16x16x32_bf16 v[0:3], v[52:55], a[136:139], v[0:3]
    v_mfma_f32_16x16x32_bf16 v[8:11], v[52:55], a[152:155], v[8:11]
    v_mfma_f32_16x16x32_bf16 v[16:19], v[52:55], a[168:171], v[16:19]
    ds_read_b128 v[52:55], v73 offset:512
    s_waitcnt lgkmcnt(3)
    v_mfma_f32_16x16x32_bf16 v[0:3], v[56:59], a[140:143], v[0:3]
    v_mfma_f32_16x16x32_bf16 v[8:11], v[56:59], a[156:159], v[8:11]
    v_mfma_f32_16x16x32_bf16 v[16:19], v[56:59], a[172:175], v[16:19]
    ds_read_b128 v[56:59], v73 offset:768
    s_waitcnt lgkmcnt(3)
    v_mfma_f32_16x16x32_bf16 v[4:7], v[44:47], a[128:131], 0
    v_mfma_f32_16x16x32_bf16 v[12:15], v[44:47], a[144:147], 0
    v_mfma_f32_16x16x32_bf16 v[20:23], v[44:47], a[160:163], 0
    s_sub_u32 s61, s51, s53
    s_mov_b32 s53, s51
    v_add_u32 v74, s61, v74
    v_add_u32 v75, s61, v75
    ds_read_b64_tr_b16 v[44:45], v74 offset:0
    ds_read_b64_tr_b16 v[46:47], v75 offset:0
    s_waitcnt lgkmcnt(4)
    v_mfma_f32_16x16x32_bf16 v[4:7], v[48:51], a[132:135], v[4:7]
    v_mfma_f32_16x16x32_bf16 v[12:15], v[48:51], a[148:151], v[12:15]
    v_mfma_f32_16x16x32_bf16 v[20:23], v[48:51], a[164:167], v[20:23]
    ds_read_b64_tr_b16 v[48:49], v74 offset:32
    ds_read_b64_tr_b16 v[50:51], v75 offset:32
    s_waitcnt lgkmcnt(5)
    v_mfma_f32_16x16x32_bf16 v[4:7], v[52:55], a[136:139], v[4:7]
    v_mfma_f32_16x16x32_bf16 v[12:15], v[52:55], a[152:155], v[12:15]
    v_mfma_f32_16x16x32_bf16 v[20:23], v[52:55], a[168:171], v[20:23]
    ds_read_b64_tr_b16 v[52:53], v74 offset:256
    ds_read_b64_tr_b16 v[54:55], v75 offset:256
    s_waitcnt lgkmcnt(6)
    v_mfma_f32_16x16x32_bf16 v[4:7], v[56:59], a[140:143], v[4:7]
    v_mfma_f32_16x16x32_bf16 v[12:15], v[56:59], a[156:159], v[12:15]
    v_mfma_f32_16x16x32_bf16 v[20:23], v[56:59], a[172:175], v[20:23]
    s_add_u32 m0, s32, s47
    s_nop 0
    buffer_load_dwordx4 v76, s[16:19], s55 offen nt lds
    s_add_u32 m0, m0, 32
    s_nop 0
    buffer_load_dwordx4 v76, s[16:19], s55 offen offset:1024 nt lds
    ds_read_b64_tr_b16 v[56:57], v74 offset:288
    ds_read_b64_tr_b16 v[58:59], v75 offset:288
    v_max3_f32 v28, v0, v1, v2
    v_max_f32 v28, v28, v3
    v_max3_f32 v28, v28, v4, v5
    v_max3_f32 v28, v28, v6, v7
    v_mov_b32 v29, v28
    s_nop 1
    v_permlane32_swap_b32 v28, v29
    v_max_f32 v28, v28, v29
    v_mov_b32 v29, v28
    s_nop 1
    v_permlane16_swap_b32 v28, v29
    v_max_f32 v28, v28, v29
    v_max_f32 v28, v28, v42
    v_sub_f32 v29, v42, v28
    v_exp_f32 v29, v29
    v_mov_b32 v42, v28
    v_mul_f32 v68, v68, v29
    v_sub_f32 v0, v0, v28
    v_sub_f32 v1, v1, v28
    v_sub_f32 v2, v2, v28
    v_sub_f32 v3, v3, v28
    v_sub_f32 v4, v4, v28
    v_sub_f32 v5, v5, v28
    v_sub_f32 v6, v6, v28
    v_sub_f32 v7, v7, v28
    v_accvgpr_read_b32 v28, a0
    v_mul_f32 v28, v28, v29
    v_accvgpr_write_b32 a0, v28
    v_accvgpr_read_b32 v28, a1
    v_mul_f32 v28, v28, v29
    v_accvgpr_write_b32 a1, v28
    v_accvgpr_read_b32 v28, a2
    v_mul_f32 v28, v28, v29
    v_accvgpr_write_b32 a2, v28
    v_accvgpr_read_b32 v28, a3
    v_mul_f32 v28, v28, v29
    v_accvgpr_write_b32 a3, v28
    v_accvgpr_read_b32 v28, a4
    v_mul_f32 v28, v28, v29
    v_accvgpr_write_b32 a4, v28
    v_accvgpr_read_b32 v28, a5
    v_mul_f32 v28, v28, v29
    v_accvgpr_write_b32 a5, v28
    v_accvgpr_read_b32 v28, a6
    v_mul_f32 v28, v28, v29
    v_accvgpr_write_b32 a6, v28
    v_accvgpr_read_b32 v28, a7
    v_mul_f32 v28, v28, v29
    v_accvgpr_write_b32 a7, v28
    v_accvgpr_read_b32 v28, a8
    v_mul_f32 v28, v28, v29
    v_accvgpr_write_b32 a8, v28
    v_accvgpr_read_b32 v28, a9
    v_mul_f32 v28, v28, v29
    v_accvgpr_write_b32 a9, v28
    v_accvgpr_read_b32 v28, a10
    v_mul_f32 v28, v28, v29
    v_accvgpr_write_b32 a10, v28
    v_accvgpr_read_b32 v28, a11
    v_mul_f32 v28, v28, v29
    v_accvgpr_write_b32 a11, v28
    v_accvgpr_read_b32 v28, a12
    v_mul_f32 v28, v28, v29
    v_accvgpr_write_b32 a12, v28
    v_accvgpr_read_b32 v28, a13
    v_mul_f32 v28, v28, v29
    v_accvgpr_write_b32 a13, v28
    v_accvgpr_read_b32 v28, a14
    v_mul_f32 v28, v28, v29
    v_accvgpr_write_b32 a14, v28
    v_accvgpr_read_b32 v28, a15
    v_mul_f32 v28, v28, v29
    v_accvgpr_write_b32 a15, v28
    v_accvgpr_read_b32 v28, a16
    v_mul_f32 v28, v28, v29
    v_accvgpr_write_b32 a16, v28
    v_accvgpr_read_b32 v28, a17
    v_mul_f32 v28, v28, v29
    v_accvgpr_write_b32 a17, v28
    v_accvgpr_read_b32 v28, a18
    v_mul_f32 v28, v28, v29
    v_accvgpr_write_b32 a18, v28
    v_accvgpr_read_b32 v28, a19
    v_mul_f32 v28, v28, v29
    v_accvgpr_write_b32 a19, v28
    v_accvgpr_read_b32 v28, a20
    v_mul_f32 v28, v28, v29
    v_accvgpr_write_b32 a20, v28
    v_accvgpr_read_b32 v28, a21
    v_mul_f32 v28, v28, v29
    v_accvgpr_write_b32 a21, v28
    v_accvgpr_read_b32 v28, a22
    v_mul_f32 v28, v28, v29
    v_accvgpr_write_b32 a22, v28
    v_accvgpr_read_b32 v28, a23
    v_mul_f32 v28, v28, v29
    v_accvgpr_write_b32 a23, v28
    v_accvgpr_read_b32 v28, a24
    v_mul_f32 v28, v28, v29
    v_accvgpr_write_b32 a24, v28
    v_accvgpr_read_b32 v28, a25
    v_mul_f32 v28, v28, v29
    v_accvgpr_write_b32 a25, v28
    v_accvgpr_read_b32 v28, a26
    v_mul_f32 v28, v28, v29
    v_accvgpr_write_b32 a26, v28
    v_accvgpr_read_b32 v28, a27
    v_mul_f32 v28, v28, v29
    v_accvgpr_write_b32 a27, v28
    v_accvgpr_read_b32 v28, a28
    v_mul_f32 v28, v28, v29
    v_accvgpr_write_b32 a28, v28
    v_accvgpr_read_b32 v28, a29
    v_mul_f32 v28, v28, v29
    v_accvgpr_write_b32 a29, v28
    v_accvgpr_read_b32 v28, a30
    v_mul_f32 v28, v28, v29
    v_accvgpr_write_b32 a30, v28
    v_accvgpr_read_b32 v28, a31
    v_mul_f32 v28, v28, v29
    v_accvgpr_write_b32 a31, v28
    v_max3_f32 v32, v8, v9, v10
    v_max_f32 v32, v32, v11
    v_max3_f32 v32, v32, v12, v13
    v_max3_f32 v32, v32, v14, v15
    v_mov_b32 v33, v32
    s_nop 1
    v_permlane32_swap_b32 v32, v33
    v_max_f32 v32, v32, v33
    v_mov_b32 v33, v32
    s_nop 1
    v_permlane16_swap_b32 v32, v33
    v_max_f32 v32, v32, v33
    v_max_f32 v32, v32, v43
    v_sub_f32 v33, v43, v32
    v_exp_f32 v33, v33
    v_mov_b32 v43, v32
    v_mul_f32 v69, v69, v33
    v_sub_f32 v8, v8, v32
    v_sub_f32 v9, v9, v32
    v_sub_f32 v10, v10, v32
    v_sub_f32 v11, v11, v32
    v_sub_f32 v12, v12, v32
    v_sub_f32 v13, v13, v32
    v_sub_f32 v14, v14, v32
    v_sub_f32 v15, v15, v32
    v_accvgpr_read_b32 v32, a32
    v_mul_f32 v32, v32, v33
    v_accvgpr_write_b32 a32, v32
    v_accvgpr_read_b32 v32, a33
    v_mul_f32 v32, v32, v33
    v_accvgpr_write_b32 a33, v32
    v_accvgpr_read_b32 v32, a34
    v_mul_f32 v32, v32, v33
    v_accvgpr_write_b32 a34, v32
    v_accvgpr_read_b32 v32, a35
    v_mul_f32 v32, v32, v33
    v_accvgpr_write_b32 a35, v32
    v_accvgpr_read_b32 v32, a36
    v_mul_f32 v32, v32, v33
    v_accvgpr_write_b32 a36, v32
    v_accvgpr_read_b32 v32, a37
    v_mul_f32 v32, v32, v33
    v_accvgpr_write_b32 a37, v32
    v_accvgpr_read_b32 v32, a38
    v_mul_f32 v32, v32, v33
    v_accvgpr_write_b32 a38, v32
    v_accvgpr_read_b32 v32, a39
    v_mul_f32 v32, v32, v33
    v_accvgpr_write_b32 a39, v32
    v_accvgpr_read_b32 v32, a40
    v_mul_f32 v32, v32, v33
    v_accvgpr_write_b32 a40, v32
    v_accvgpr_read_b32 v32, a41
    v_mul_f32 v32, v32, v33
    v_accvgpr_write_b32 a41, v32
    v_accvgpr_read_b32 v32, a42
    v_mul_f32 v32, v32, v33
    v_accvgpr_write_b32 a42, v32
    v_accvgpr_read_b32 v32, a43
    v_mul_f32 v32, v32, v33
    v_accvgpr_write_b32 a43, v32
    v_accvgpr_read_b32 v32, a44
    v_mul_f32 v32, v32, v33
    v_accvgpr_write_b32 a44, v32
    v_accvgpr_read_b32 v32, a45
    v_mul_f32 v32, v32, v33
    v_accvgpr_write_b32 a45, v32
    v_accvgpr_read_b32 v32, a46
    v_mul_f32 v32, v32, v33
    v_accvgpr_write_b32 a46, v32
    v_accvgpr_read_b32 v32, a47
    v_mul_f32 v32, v32, v33
    v_accvgpr_write_b32 a47, v32
    v_accvgpr_read_b32 v32, a48
    v_mul_f32 v32, v32, v33
    v_accvgpr_write_b32 a48, v32
    v_accvgpr_read_b32 v32, a49
    v_mul_f32 v32, v32, v33
    v_accvgpr_write_b32 a49, v32
    v_accvgpr_read_b32 v32, a50
    v_mul_f32 v32, v32, v33
    v_accvgpr_write_b32 a50, v32
    v_accvgpr_read_b32 v32, a51
    v_mul_f32 v32, v32, v33
    v_accvgpr_write_b32 a51, v32
    v_accvgpr_read_b32 v32, a52
    v_mul_f32 v32, v32, v33
    v_accvgpr_write_b32 a52, v32
    v_accvgpr_read_b32 v32, a53
    v_mul_f32 v32, v32, v33
    v_accvgpr_write_b32 a53, v32
    v_accvgpr_read_b32 v32, a54
    v_mul_f32 v32, v32, v33
    v_accvgpr_write_b32 a54, v32
    v_accvgpr_read_b32 v32, a55
    v_mul_f32 v32, v32, v33
    v_accvgpr_write_b32 a55, v32
    v_accvgpr_read_b32 v32, a56
    v_mul_f32 v32, v32, v33
    v_accvgpr_write_b32 a56, v32
    v_accvgpr_read_b32 v32, a57
    v_mul_f32 v32, v32, v33
    v_accvgpr_write_b32 a57, v32
    v_accvgpr_read_b32 v32, a58
    v_mul_f32 v32, v32, v33
    v_accvgpr_write_b32 a58, v32
    v_accvgpr_read_b32 v32, a59
    v_mul_f32 v32, v32, v33
    v_accvgpr_write_b32 a59, v32
    v_accvgpr_read_b32 v32, a60
    v_mul_f32 v32, v32, v33
    v_accvgpr_write_b32 a60, v32
    v_accvgpr_read_b32 v32, a61
    v_mul_f32 v32, v32, v33
    v_accvgpr_write_b32 a61, v32
    v_accvgpr_read_b32 v32, a62
    v_mul_f32 v32, v32, v33
    v_accvgpr_write_b32 a62, v32
    v_accvgpr_read_b32 v32, a63
    v_mul_f32 v32, v32, v33
    v_accvgpr_write_b32 a63, v32
    v_max3_f32 v36, v16, v17, v18
    v_max_f32 v36, v36, v19
    v_max3_f32 v36, v36, v20, v21
    v_max3_f32 v36, v36, v22, v23
    v_mov_b32 v37, v36
    s_nop 1
    v_permlane32_swap_b32 v36, v37
    v_max_f32 v36, v36, v37
    v_mov_b32 v37, v36
    s_nop 1
    v_permlane16_swap_b32 v36, v37
    v_max_f32 v36, v36, v37
    v_max_f32 v36, v36, v78
    v_sub_f32 v37, v78, v36
    v_exp_f32 v37, v37
    v_mov_b32 v78, v36
    v_mul_f32 v70, v70, v37
    v_sub_f32 v16, v16, v36
    v_sub_f32 v17, v17, v36
    v_sub_f32 v18, v18, v36
    v_sub_f32 v19, v19, v36
    v_sub_f32 v20, v20, v36
    v_sub_f32 v21, v21, v36
    v_sub_f32 v22, v22, v36
    v_sub_f32 v23, v23, v36
    v_accvgpr_read_b32 v36, a64
    v_mul_f32 v36, v36, v37
    v_accvgpr_write_b32 a64, v36
    v_accvgpr_read_b32 v36, a65
    v_mul_f32 v36, v36, v37
    v_accvgpr_write_b32 a65, v36
    v_accvgpr_read_b32 v36, a66
    v_mul_f32 v36, v36, v37
    v_accvgpr_write_b32 a66, v36
    v_accvgpr_read_b32 v36, a67
    v_mul_f32 v36, v36, v37
    v_accvgpr_write_b32 a67, v36
    v_accvgpr_read_b32 v36, a68
    v_mul_f32 v36, v36, v37
    v_accvgpr_write_b32 a68, v36
    v_accvgpr_read_b32 v36, a69
    v_mul_f32 v36, v36, v37
    v_accvgpr_write_b32 a69, v36
    v_accvgpr_read_b32 v36, a70
    v_mul_f32 v36, v36, v37
    v_accvgpr_write_b32 a70, v36
    v_accvgpr_read_b32 v36, a71
    v_mul_f32 v36, v36, v37
    v_accvgpr_write_b32 a71, v36
    v_accvgpr_read_b32 v36, a72
    v_mul_f32 v36, v36, v37
    v_accvgpr_write_b32 a72, v36
    v_accvgpr_read_b32 v36, a73
    v_mul_f32 v36, v36, v37
    v_accvgpr_write_b32 a73, v36
    v_accvgpr_read_b32 v36, a74
    v_mul_f32 v36, v36, v37
    v_accvgpr_write_b32 a74, v36
    v_accvgpr_read_b32 v36, a75
    v_mul_f32 v36, v36, v37
    v_accvgpr_write_b32 a75, v36
    v_accvgpr_read_b32 v36, a76
    v_mul_f32 v36, v36, v37
    v_accvgpr_write_b32 a76, v36
    v_accvgpr_read_b32 v36, a77
    v_mul_f32 v36, v36, v37
    v_accvgpr_write_b32 a77, v36
    v_accvgpr_read_b32 v36, a78
    v_mul_f32 v36, v36, v37
    v_accvgpr_write_b32 a78, v36
    v_accvgpr_read_b32 v36, a79
    v_mul_f32 v36, v36, v37
    v_accvgpr_write_b32 a79, v36
    v_accvgpr_read_b32 v36, a80
    v_mul_f32 v36, v36, v37
    v_accvgpr_write_b32 a80, v36
    v_accvgpr_read_b32 v36, a81
    v_mul_f32 v36, v36, v37
    v_accvgpr_write_b32 a81, v36
    v_accvgpr_read_b32 v36, a82
    v_mul_f32 v36, v36, v37
    v_accvgpr_write_b32 a82, v36
    v_accvgpr_read_b32 v36, a83
    v_mul_f32 v36, v36, v37
    v_accvgpr_write_b32 a83, v36
    v_accvgpr_read_b32 v36, a84
    v_mul_f32 v36, v36, v37
    v_accvgpr_write_b32 a84, v36
    v_accvgpr_read_b32 v36, a85
    v_mul_f32 v36, v36, v37
    v_accvgpr_write_b32 a85, v36
    v_accvgpr_read_b32 v36, a86
    v_mul_f32 v36, v36, v37
    v_accvgpr_write_b32 a86, v36
    v_accvgpr_read_b32 v36, a87
    v_mul_f32 v36, v36, v37
    v_accvgpr_write_b32 a87, v36
    v_accvgpr_read_b32 v36, a88
    v_mul_f32 v36, v36, v37
    v_accvgpr_write_b32 a88, v36
    v_accvgpr_read_b32 v36, a89
    v_mul_f32 v36, v36, v37
    v_accvgpr_write_b32 a89, v36
    v_accvgpr_read_b32 v36, a90
    v_mul_f32 v36, v36, v37
    v_accvgpr_write_b32 a90, v36
    v_accvgpr_read_b32 v36, a91
    v_mul_f32 v36, v36, v37
    v_accvgpr_write_b32 a91, v36
    v_accvgpr_read_b32 v36, a92
    v_mul_f32 v36, v36, v37
    v_accvgpr_write_b32 a92, v36
    v_accvgpr_read_b32 v36, a93
    v_mul_f32 v36, v36, v37
    v_accvgpr_write_b32 a93, v36
    v_accvgpr_read_b32 v36, a94
    v_mul_f32 v36, v36, v37
    v_accvgpr_write_b32 a94, v36
    v_accvgpr_read_b32 v36, a95
    v_mul_f32 v36, v36, v37
    v_accvgpr_write_b32 a95, v36
    v_exp_f32 v0, v0
    v_exp_f32 v1, v1
    v_exp_f32 v2, v2
    v_exp_f32 v3, v3
    v_cvt_pk_bf16_f32 v28, v0, v1
    v_cvt_pk_bf16_f32 v29, v2, v3
    v_exp_f32 v4, v4
    v_exp_f32 v5, v5
    v_exp_f32 v6, v6
    v_exp_f32 v7, v7
    v_cvt_pk_bf16_f32 v30, v4, v5
    v_cvt_pk_bf16_f32 v31, v6, v7
    v_exp_f32 v8, v8
    v_exp_f32 v9, v9
    v_exp_f32 v10, v10
    v_exp_f32 v11, v11
    v_cvt_pk_bf16_f32 v32, v8, v9
    v_cvt_pk_bf16_f32 v33, v10, v11
    v_exp_f32 v12, v12
    v_exp_f32 v13, v13
    v_exp_f32 v14, v14
    v_exp_f32 v15, v15
    v_cvt_pk_bf16_f32 v34, v12, v13
    v_cvt_pk_bf16_f32 v35, v14, v15
    v_exp_f32 v16, v16
    v_exp_f32 v17, v17
    v_exp_f32 v18, v18
    v_exp_f32 v19, v19
    v_cvt_pk_bf16_f32 v36, v16, v17
    v_cvt_pk_bf16_f32 v37, v18, v19
    v_exp_f32 v20, v20
    v_exp_f32 v21, v21
    v_exp_f32 v22, v22
    v_exp_f32 v23, v23
    v_cvt_pk_bf16_f32 v38, v20, v21
    v_cvt_pk_bf16_f32 v39, v22, v23
    s_waitcnt lgkmcnt(6)
    v_mfma_f32_16x16x32_bf16 a[0:3], v[44:47], v[28:31], a[0:3]
    v_add_f32 v68, v68, v0
    v_mfma_f32_16x16x32_bf16 a[32:35], v[44:47], v[32:35], a[32:35]
    v_add_f32 v68, v68, v1
    v_mfma_f32_16x16x32_bf16 a[64:67], v[44:47], v[36:39], a[64:67]
    v_add_f32 v68, v68, v2
    ds_read_b64_tr_b16 v[44:45], v74 offset:512
    ds_read_b64_tr_b16 v[46:47], v75 offset:512
    s_waitcnt lgkmcnt(6)
    v_mfma_f32_16x16x32_bf16 a[4:7], v[48:51], v[28:31], a[4:7]
    v_add_f32 v68, v68, v3
    v_mfma_f32_16x16x32_bf16 a[36:39], v[48:51], v[32:35], a[36:39]
    v_add_f32 v69, v69, v8
    v_mfma_f32_16x16x32_bf16 a[68:71], v[48:51], v[36:39], a[68:71]
    v_add_f32 v69, v69, v9
    ds_read_b64_tr_b16 v[48:49], v74 offset:544
    ds_read_b64_tr_b16 v[50:51], v75 offset:544
    s_waitcnt lgkmcnt(6)
    v_mfma_f32_16x16x32_bf16 a[8:11], v[52:55], v[28:31], a[8:11]
    v_add_f32 v69, v69, v10
    v_mfma_f32_16x16x32_bf16 a[40:43], v[52:55], v[32:35], a[40:43]
    v_add_f32 v69, v69, v11
    v_mfma_f32_16x16x32_bf16 a[72:75], v[52:55], v[36:39], a[72:75]
    v_add_f32 v70, v70, v16
    ds_read_b64_tr_b16 v[52:53], v74 offset:768
    ds_read_b64_tr_b16 v[54:55], v75 offset:768
    s_waitcnt lgkmcnt(6)
    v_mfma_f32_16x16x32_bf16 a[12:15], v[56:59], v[28:31], a[12:15]
    v_add_f32 v70, v70, v17
    v_mfma_f32_16x16x32_bf16 a[44:47], v[56:59], v[32:35], a[44:47]
    v_add_f32 v70, v70, v18
    v_mfma_f32_16x16x32_bf16 a[76:79], v[56:59], v[36:39], a[76:79]
    v_add_f32 v70, v70, v19
    ds_read_b64_tr_b16 v[56:57], v74 offset:800
    ds_read_b64_tr_b16 v[58:59], v75 offset:800
    s_waitcnt lgkmcnt(6)
    v_mfma_f32_16x16x32_bf16 a[16:19], v[44:47], v[28:31], a[16:19]
    v_add_f32 v68, v68, v4
    v_mfma_f32_16x16x32_bf16 a[48:51], v[44:47], v[32:35], a[48:51]
    v_add_f32 v68, v68, v5
    v_mfma_f32_16x16x32_bf16 a[80:83], v[44:47], v[36:39], a[80:83]
    v_add_f32 v68, v68, v6
    s_waitcnt lgkmcnt(4)
    v_mfma_f32_16x16x32_bf16 a[20:23], v[48:51], v[28:31], a[20:23]
    v_add_f32 v68, v68, v7
    v_mfma_f32_16x16x32_bf16 a[52:55], v[48:51], v[32:35], a[52:55]
    v_add_f32 v69, v69, v12
    v_mfma_f32_16x16x32_bf16 a[84:87], v[48:51], v[36:39], a[84:87]
    v_add_f32 v69, v69, v13
    s_waitcnt lgkmcnt(2)
    v_mfma_f32_16x16x32_bf16 a[24:27], v[52:55], v[28:31], a[24:27]
    v_add_f32 v69, v69, v14
    v_mfma_f32_16x16x32_bf16 a[56:59], v[52:55], v[32:35], a[56:59]
    v_add_f32 v69, v69, v15
    v_mfma_f32_16x16x32_bf16 a[88:91], v[52:55], v[36:39], a[88:91]
    v_add_f32 v70, v70, v20
    s_waitcnt lgkmcnt(0)
    v_mfma_f32_16x16x32_bf16 a[28:31], v[56:59], v[28:31], a[28:31]
    v_add_f32 v70, v70, v21
    v_mfma_f32_16x16x32_bf16 a[60:63], v[56:59], v[32:35], a[60:63]
    v_add_f32 v70, v70, v22
    v_mfma_f32_16x16x32_bf16 a[92:95], v[56:59], v[36:39], a[92:95]
    v_add_f32 v70, v70, v23
    s_add_u32 s38, s38, 16384
    s_add_u32 s37, s37, 1
    s_cmp_lt_u32 s37, 16
    s_cbranch_scc1 L_attn_safe
    s_branch L_epi
L_k1_end:
    s_endpgm
.globl oproj_kernel
.p2align 8
.type oproj_kernel,@function
oproj_kernel:
    s_cmp_ge_u32 s2, 256
    s_cbranch_scc1 L_k2_end
    s_load_dwordx2 s[64:65], s[0:1], 32
    s_load_dwordx2 s[66:67], s[0:1], 72
    s_load_dwordx2 s[68:69], s[0:1], 80
    s_load_dwordx2 s[70:71], s[0:1], 96
    s_and_b32 s3, s2, 7
    s_lshr_b32 s4, s2, 3
    s_lshr_b32 s5, s3, 2
    s_and_b32 s6, s3, 3
    s_lshl_b32 s6, s6, 1
    s_lshr_b32 s7, s4, 4
    s_add_u32 s6, s6, s7
    s_and_b32 s4, s4, 15
    s_lshr_b32 s7, s4, 1
    s_and_b32 s4, s4, 1
    s_mul_i32 s30, s4, 6
    v_lshrrev_b32 v1, 6, v0
    v_mov_b32 v9, v0
    v_and_b32 v0, 63, v0
    v_readfirstlane_b32 s28, v1
    s_waitcnt lgkmcnt(0)
    s_cmp_eq_u32 s5, 0
    s_cselect_b64 s[72:73], s[64:65], s[66:67]
    s_lshl_b32 s3, s5, 3
    s_add_u32 s3, s3, s7
    s_mul_i32 s3, s3, 655360
    s_add_u32 s3, s3, 62914560
    s_add_u32 s72, s70, s3
    s_addc_u32 s73, s71, 0
    s_mov_b32 s8, s72
    s_and_b32 s9, s73, 0xffff
    s_mov_b32 s10, 655360
    s_mov_b32 s11, 0x20000
    s_lshl_b32 s3, s5, 3
    s_add_u32 s3, s3, s6
    s_mul_i32 s3, s3, 1703936
    s_add_u32 s70, s70, s3
    s_addc_u32 s71, s71, 0
    s_mov_b32 s12, s70
    s_and_b32 s13, s71, 0xffff
    s_mov_b32 s14, 1703936
    s_mov_b32 s15, 0x20000
    s_mov_b32 s16, s68
    s_and_b32 s17, s69, 0xffff
    s_mov_b32 s18, 4259840
    s_mov_b32 s19, 0x20000
    s_mul_i32 s31, s6, 208
    s_lshl_b32 s3, s30, 4
    s_add_u32 s31, s31, s3
    s_mul_i32 s31, s31, 2560
    s_mul_i32 s3, s5, 1280
    s_add_u32 s31, s31, s3
    s_mul_i32 s3, s7, 160
    s_add_u32 s31, s31, s3
    s_lshl_b32 s3, s28, 14
    s_lshl_b32 s32, s30, 17
    s_add_u32 s32, s32, s3
    s_add_u32 s33, s32, 131072
    s_add_u32 s34, s32, 262144
    s_add_u32 s35, s32, 393216
    s_add_u32 s36, s32, 524288
    s_add_u32 s37, s32, 655360
    s_add_u32 s38, s32, 786432
    s_mul_i32 s40, s28, 81920
    s_mul_i32 s41, s28, 20480
    v_lshlrev_b32 v2, 4, v0
    v_lshlrev_b32 v3, 4, v0
    s_add_u32 m0, s41, 0
    s_nop 0
    buffer_load_dwordx4 v3, s[8:11], s40 offen lds
    s_add_u32 m0, s41, 0
    s_nop 0
    buffer_load_dwordx4 v3, s[8:11], s40 offen offset:1024 lds
    s_add_u32 m0, s41, 0
    s_nop 0
    buffer_load_dwordx4 v3, s[8:11], s40 offen offset:2048 lds
    s_add_u32 m0, s41, 0
    s_nop 0
    buffer_load_dwordx4 v3, s[8:11], s40 offen offset:3072 lds
    s_add_u32 s40, s40, 4096
    s_add_u32 m0, s41, 4096
    s_nop 0
    buffer_load_dwordx4 v3, s[8:11], s40 offen lds
    s_add_u32 s40, s40, 1024
    s_add_u32 m0, s41, 5120
    s_nop 0
    buffer_load_dwordx4 v3, s[8:11], s40 offen lds
    s_add_u32 m0, s41, 5120
    s_nop 0
    buffer_load_dwordx4 v3, s[8:11], s40 offen offset:1024 lds
    s_add_u32 m0, s41, 5120
    s_nop 0
    buffer_load_dwordx4 v3, s[8:11], s40 offen offset:2048 lds
    s_add_u32 m0, s41, 5120
    s_nop 0
    buffer_load_dwordx4 v3, s[8:11], s40 offen offset:3072 lds
    s_add_u32 s40, s40, 4096
    s_add_u32 m0, s41, 9216
    s_nop 0
    buffer_load_dwordx4 v3, s[8:11], s40 offen lds
    s_add_u32 s40, s40, 1024
    buffer_load_dwordx4 v[12:15], v2, s[12:15], s32 offen
    buffer_load_dwordx4 v[16:19], v2, s[12:15], s33 offen
    buffer_load_dwordx4 v[20:23], v2, s[12:15], s34 offen
    buffer_load_dwordx4 v[24:27], v2, s[12:15], s35 offen
    buffer_load_dwordx4 v[28:31], v2, s[12:15], s36 offen
    buffer_load_dwordx4 v[32:35], v2, s[12:15], s37 offen
    buffer_load_dwordx4 v[36:39], v2, s[12:15], s38 offen
    s_add_u32 m0, s41, 10240
    s_nop 0
    buffer_load_dwordx4 v3, s[8:11], s40 offen lds
    s_add_u32 m0, s41, 10240
    s_nop 0
    buffer_load_dwordx4 v3, s[8:11], s40 offen offset:1024 lds
    s_add_u32 m0, s41, 10240
    s_nop 0
    buffer_load_dwordx4 v3, s[8:11], s40 offen offset:2048 lds
    s_add_u32 m0, s41, 10240
    s_nop 0
    buffer_load_dwordx4 v3, s[8:11], s40 offen offset:3072 lds
    s_add_u32 s40, s40, 4096
    s_add_u32 m0, s41, 14336
    s_nop 0
    buffer_load_dwordx4 v3, s[8:11], s40 offen lds
    s_add_u32 s40, s40, 1024
    buffer_load_dwordx4 v[40:43], v2, s[12:15], s32 offen offset:1024
    buffer_load_dwordx4 v[44:47], v2, s[12:15], s33 offen offset:1024
    buffer_load_dwordx4 v[48:51], v2, s[12:15], s34 offen offset:1024
    buffer_load_dwordx4 v[52:55], v2, s[12:15], s35 offen offset:1024
    buffer_load_dwordx4 v[56:59], v2, s[12:15], s36 offen offset:1024
    buffer_load_dwordx4 v[60:63], v2, s[12:15], s37 offen offset:1024
    buffer_load_dwordx4 v[64:67], v2, s[12:15], s38 offen offset:1024
    v_add_u32 v8, s41, v3
    v_accvgpr_write_b32 a0, 0
    v_accvgpr_write_b32 a1, 0
    v_accvgpr_write_b32 a2, 0
    v_accvgpr_write_b32 a3, 0
    v_accvgpr_write_b32 a4, 0
    v_accvgpr_write_b32 a5, 0
    v_accvgpr_write_b32 a6, 0
    v_accvgpr_write_b32 a7, 0
    v_accvgpr_write_b32 a8, 0
    v_accvgpr_write_b32 a9, 0
    v_accvgpr_write_b32 a10, 0
    v_accvgpr_write_b32 a11, 0
    v_accvgpr_write_b32 a12, 0
    v_accvgpr_write_b32 a13, 0
    v_accvgpr_write_b32 a14, 0
    v_accvgpr_write_b32 a15, 0
    v_accvgpr_write_b32 a16, 0
    v_accvgpr_write_b32 a17, 0
    v_accvgpr_write_b32 a18, 0
    v_accvgpr_write_b32 a19, 0
    v_accvgpr_write_b32 a20, 0
    v_accvgpr_write_b32 a21, 0
    v_accvgpr_write_b32 a22, 0
    v_accvgpr_write_b32 a23, 0
    v_accvgpr_write_b32 a24, 0
    v_accvgpr_write_b32 a25, 0
    v_accvgpr_write_b32 a26, 0
    v_accvgpr_write_b32 a27, 0
    v_accvgpr_write_b32 a28, 0
    v_accvgpr_write_b32 a29, 0
    v_accvgpr_write_b32 a30, 0
    v_accvgpr_write_b32 a31, 0
    v_accvgpr_write_b32 a32, 0
    v_accvgpr_write_b32 a33, 0
    v_accvgpr_write_b32 a34, 0
    v_accvgpr_write_b32 a35, 0
    v_accvgpr_write_b32 a36, 0
    v_accvgpr_write_b32 a37, 0
    v_accvgpr_write_b32 a38, 0
    v_accvgpr_write_b32 a39, 0
    v_accvgpr_write_b32 a40, 0
    v_accvgpr_write_b32 a41, 0
    v_accvgpr_write_b32 a42, 0
    v_accvgpr_write_b32 a43, 0
    v_accvgpr_write_b32 a44, 0
    v_accvgpr_write_b32 a45, 0
    v_accvgpr_write_b32 a46, 0
    v_accvgpr_write_b32 a47, 0
    v_accvgpr_write_b32 a48, 0
    v_accvgpr_write_b32 a49, 0
    v_accvgpr_write_b32 a50, 0
    v_accvgpr_write_b32 a51, 0
    v_accvgpr_write_b32 a52, 0
    v_accvgpr_write_b32 a53, 0
    v_accvgpr_write_b32 a54, 0
    v_accvgpr_write_b32 a55, 0
    v_accvgpr_write_b32 a56, 0
    v_accvgpr_write_b32 a57, 0
    v_accvgpr_write_b32 a58, 0
    v_accvgpr_write_b32 a59, 0
    v_accvgpr_write_b32 a60, 0
    v_accvgpr_write_b32 a61, 0
    v_accvgpr_write_b32 a62, 0
    v_accvgpr_write_b32 a63, 0
    v_accvgpr_write_b32 a64, 0
    v_accvgpr_write_b32 a65, 0
    v_accvgpr_write_b32 a66, 0
    v_accvgpr_write_b32 a67, 0
    v_accvgpr_write_b32 a68, 0
    v_accvgpr_write_b32 a69, 0
    v_accvgpr_write_b32 a70, 0
    v_accvgpr_write_b32 a71, 0
    v_accvgpr_write_b32 a72, 0
    v_accvgpr_write_b32 a73, 0
    v_accvgpr_write_b32 a74, 0
    v_accvgpr_write_b32 a75, 0
    v_accvgpr_write_b32 a76, 0
    v_accvgpr_write_b32 a77, 0
    v_accvgpr_write_b32 a78, 0
    v_accvgpr_write_b32 a79, 0
    v_accvgpr_write_b32 a80, 0
    v_accvgpr_write_b32 a81, 0
    v_accvgpr_write_b32 a82, 0
    v_accvgpr_write_b32 a83, 0
    v_accvgpr_write_b32 a84, 0
    v_accvgpr_write_b32 a85, 0
    v_accvgpr_write_b32 a86, 0
    v_accvgpr_write_b32 a87, 0
    v_accvgpr_write_b32 a88, 0
    v_accvgpr_write_b32 a89, 0
    v_accvgpr_write_b32 a90, 0
    v_accvgpr_write_b32 a91, 0
    v_accvgpr_write_b32 a92, 0
    v_accvgpr_write_b32 a93, 0
    v_accvgpr_write_b32 a94, 0
    v_accvgpr_write_b32 a95, 0
    v_accvgpr_write_b32 a96, 0
    v_accvgpr_write_b32 a97, 0
    v_accvgpr_write_b32 a98, 0
    v_accvgpr_write_b32 a99, 0
    v_accvgpr_write_b32 a100, 0
    v_accvgpr_write_b32 a101, 0
    v_accvgpr_write_b32 a102, 0
    v_accvgpr_write_b32 a103, 0
    v_accvgpr_write_b32 a104, 0
    v_accvgpr_write_b32 a105, 0
    v_accvgpr_write_b32 a106, 0
    v_accvgpr_write_b32 a107, 0
    v_accvgpr_write_b32 a108, 0
    v_accvgpr_write_b32 a109, 0
    v_accvgpr_write_b32 a110, 0
    v_accvgpr_write_b32 a111, 0
    v_accvgpr_write_b32 a112, 0
    v_accvgpr_write_b32 a113, 0
    v_accvgpr_write_b32 a114, 0
    v_accvgpr_write_b32 a115, 0
    v_accvgpr_write_b32 a116, 0
    v_accvgpr_write_b32 a117, 0
    v_accvgpr_write_b32 a118, 0
    v_accvgpr_write_b32 a119, 0
    v_accvgpr_write_b32 a120, 0
    v_accvgpr_write_b32 a121, 0
    v_accvgpr_write_b32 a122, 0
    v_accvgpr_write_b32 a123, 0
    v_accvgpr_write_b32 a124, 0
    v_accvgpr_write_b32 a125, 0
    v_accvgpr_write_b32 a126, 0
    v_accvgpr_write_b32 a127, 0
    v_accvgpr_write_b32 a128, 0
    v_accvgpr_write_b32 a129, 0
    v_accvgpr_write_b32 a130, 0
    v_accvgpr_write_b32 a131, 0
    v_accvgpr_write_b32 a132, 0
    v_accvgpr_write_b32 a133, 0
    v_accvgpr_write_b32 a134, 0
    v_accvgpr_write_b32 a135, 0
    v_accvgpr_write_b32 a136, 0
    v_accvgpr_write_b32 a137, 0
    v_accvgpr_write_b32 a138, 0
    v_accvgpr_write_b32 a139, 0
    s_waitcnt vmcnt(24)
    ds_read_b128 v[68:71], v8 offset:0
    ds_read_b128 v[72:75], v8 offset:1024
    ds_read_b128 v[76:79], v8 offset:2048
    ds_read_b128 v[80:83], v8 offset:3072
    ds_read_b128 v[84:87], v8 offset:4096
    s_mov_b32 s42, 0
    s_nop 9
L_k2_loop:
    s_waitcnt vmcnt(12)
    s_waitcnt lgkmcnt(4)
    v_mfma_f32_16x16x32_bf16 a[0:3], v[68:71], v[12:15], a[0:3]
    s_waitcnt lgkmcnt(3)
    v_mfma_f32_16x16x32_bf16 a[4:7], v[72:75], v[12:15], a[4:7]
    ds_read_b128 v[88:91], v8 offset:5120
    s_waitcnt lgkmcnt(3)
    v_mfma_f32_16x16x32_bf16 a[8:11], v[76:79], v[12:15], a[8:11]
    s_waitcnt lgkmcnt(2)
    v_mfma_f32_16x16x32_bf16 a[12:15], v[80:83], v[12:15], a[12:15]
    s_waitcnt lgkmcnt(1)
    v_mfma_f32_16x16x32_bf16 a[16:19], v[84:87], v[12:15], a[16:19]
    buffer_load_dwordx4 v[12:15], v2, s[12:15], s32 offen offset:2048
    v_mfma_f32_16x16x32_bf16 a[20:23], v[68:71], v[16:19], a[20:23]
    v_mfma_f32_16x16x32_bf16 a[24:27], v[72:75], v[16:19], a[24:27]
    ds_read_b128 v[92:95], v8 offset:6144
    v_mfma_f32_16x16x32_bf16 a[28:31], v[76:79], v[16:19], a[28:31]
    v_mfma_f32_16x16x32_bf16 a[32:35], v[80:83], v[16:19], a[32:35]
    s_add_u32 m0, s41, 15360
    s_nop 0
    buffer_load_dwordx4 v3, s[8:11], s40 offen lds
    v_mfma_f32_16x16x32_bf16 a[36:39], v[84:87], v[16:19], a[36:39]
    buffer_load_dwordx4 v[16:19], v2, s[12:15], s33 offen offset:2048
    v_mfma_f32_16x16x32_bf16 a[40:43], v[68:71], v[20:23], a[40:43]
    v_mfma_f32_16x16x32_bf16 a[44:47], v[72:75], v[20:23], a[44:47]
    ds_read_b128 v[96:99], v8 offset:7168
    v_mfma_f32_16x16x32_bf16 a[48:51], v[76:79], v[20:23], a[48:51]
    v_mfma_f32_16x16x32_bf16 a[52:55], v[80:83], v[20:23], a[52:55]
    s_add_u32 m0, s41, 15360
    s_nop 0
    buffer_load_dwordx4 v3, s[8:11], s40 offen offset:1024 lds
    v_mfma_f32_16x16x32_bf16 a[56:59], v[84:87], v[20:23], a[56:59]
    buffer_load_dwordx4 v[20:23], v2, s[12:15], s34 offen offset:2048
    v_mfma_f32_16x16x32_bf16 a[60:63], v[68:71], v[24:27], a[60:63]
    v_mfma_f32_16x16x32_bf16 a[64:67], v[72:75], v[24:27], a[64:67]
    ds_read_b128 v[100:103], v8 offset:8192
    v_mfma_f32_16x16x32_bf16 a[68:71], v[76:79], v[24:27], a[68:71]
    v_mfma_f32_16x16x32_bf16 a[72:75], v[80:83], v[24:27], a[72:75]
    s_add_u32 m0, s41, 15360
    s_nop 0
    buffer_load_dwordx4 v3, s[8:11], s40 offen offset:2048 lds
    v_mfma_f32_16x16x32_bf16 a[76:79], v[84:87], v[24:27], a[76:79]
    buffer_load_dwordx4 v[24:27], v2, s[12:15], s35 offen offset:2048
    v_mfma_f32_16x16x32_bf16 a[80:83], v[68:71], v[28:31], a[80:83]
    v_mfma_f32_16x16x32_bf16 a[84:87], v[72:75], v[28:31], a[84:87]
    ds_read_b128 v[104:107], v8 offset:9216
    v_mfma_f32_16x16x32_bf16 a[88:91], v[76:79], v[28:31], a[88:91]
    v_mfma_f32_16x16x32_bf16 a[92:95], v[80:83], v[28:31], a[92:95]
    s_add_u32 m0, s41, 15360
    s_nop 0
    buffer_load_dwordx4 v3, s[8:11], s40 offen offset:3072 lds
    v_mfma_f32_16x16x32_bf16 a[96:99], v[84:87], v[28:31], a[96:99]
    buffer_load_dwordx4 v[28:31], v2, s[12:15], s36 offen offset:2048
    v_mfma_f32_16x16x32_bf16 a[100:103], v[68:71], v[32:35], a[100:103]
    v_mfma_f32_16x16x32_bf16 a[104:107], v[72:75], v[32:35], a[104:107]
    v_mfma_f32_16x16x32_bf16 a[108:111], v[76:79], v[32:35], a[108:111]
    v_mfma_f32_16x16x32_bf16 a[112:115], v[80:83], v[32:35], a[112:115]
    s_add_u32 s40, s40, 4096
    s_add_u32 m0, s41, 19456
    s_nop 0
    buffer_load_dwordx4 v3, s[8:11], s40 offen lds
    s_add_u32 s40, s40, 1024
    v_mfma_f32_16x16x32_bf16 a[116:119], v[84:87], v[32:35], a[116:119]
    buffer_load_dwordx4 v[32:35], v2, s[12:15], s37 offen offset:2048
    v_mfma_f32_16x16x32_bf16 a[120:123], v[68:71], v[36:39], a[120:123]
    v_mfma_f32_16x16x32_bf16 a[124:127], v[72:75], v[36:39], a[124:127]
    v_mfma_f32_16x16x32_bf16 a[128:131], v[76:79], v[36:39], a[128:131]
    v_mfma_f32_16x16x32_bf16 a[132:135], v[80:83], v[36:39], a[132:135]
    v_mfma_f32_16x16x32_bf16 a[136:139], v[84:87], v[36:39], a[136:139]
    buffer_load_dwordx4 v[36:39], v2, s[12:15], s38 offen offset:2048
    s_waitcnt vmcnt(12)
    s_waitcnt lgkmcnt(4)
    v_mfma_f32_16x16x32_bf16 a[0:3], v[88:91], v[40:43], a[0:3]
    s_waitcnt lgkmcnt(3)
    v_mfma_f32_16x16x32_bf16 a[4:7], v[92:95], v[40:43], a[4:7]
    ds_read_b128 v[68:71], v8 offset:10240
    s_waitcnt lgkmcnt(3)
    v_mfma_f32_16x16x32_bf16 a[8:11], v[96:99], v[40:43], a[8:11]
    s_waitcnt lgkmcnt(2)
    v_mfma_f32_16x16x32_bf16 a[12:15], v[100:103], v[40:43], a[12:15]
    s_waitcnt lgkmcnt(1)
    v_mfma_f32_16x16x32_bf16 a[16:19], v[104:107], v[40:43], a[16:19]
    buffer_load_dwordx4 v[40:43], v2, s[12:15], s32 offen offset:3072
    v_mfma_f32_16x16x32_bf16 a[20:23], v[88:91], v[44:47], a[20:23]
    v_mfma_f32_16x16x32_bf16 a[24:27], v[92:95], v[44:47], a[24:27]
    ds_read_b128 v[72:75], v8 offset:11264
    v_mfma_f32_16x16x32_bf16 a[28:31], v[96:99], v[44:47], a[28:31]
    v_mfma_f32_16x16x32_bf16 a[32:35], v[100:103], v[44:47], a[32:35]
    s_add_u32 m0, s41, 0
    s_nop 0
    buffer_load_dwordx4 v3, s[8:11], s40 offen lds
    v_mfma_f32_16x16x32_bf16 a[36:39], v[104:107], v[44:47], a[36:39]
    buffer_load_dwordx4 v[44:47], v2, s[12:15], s33 offen offset:3072
    v_mfma_f32_16x16x32_bf16 a[40:43], v[88:91], v[48:51], a[40:43]
    v_mfma_f32_16x16x32_bf16 a[44:47], v[92:95], v[48:51], a[44:47]
    ds_read_b128 v[76:79], v8 offset:12288
    v_mfma_f32_16x16x32_bf16 a[48:51], v[96:99], v[48:51], a[48:51]
    v_mfma_f32_16x16x32_bf16 a[52:55], v[100:103], v[48:51], a[52:55]
    s_add_u32 m0, s41, 0
    s_nop 0
    buffer_load_dwordx4 v3, s[8:11], s40 offen offset:1024 lds
    v_mfma_f32_16x16x32_bf16 a[56:59], v[104:107], v[48:51], a[56:59]
    buffer_load_dwordx4 v[48:51], v2, s[12:15], s34 offen offset:3072
    v_mfma_f32_16x16x32_bf16 a[60:63], v[88:91], v[52:55], a[60:63]
    v_mfma_f32_16x16x32_bf16 a[64:67], v[92:95], v[52:55], a[64:67]
    ds_read_b128 v[80:83], v8 offset:13312
    v_mfma_f32_16x16x32_bf16 a[68:71], v[96:99], v[52:55], a[68:71]
    v_mfma_f32_16x16x32_bf16 a[72:75], v[100:103], v[52:55], a[72:75]
    s_add_u32 m0, s41, 0
    s_nop 0
    buffer_load_dwordx4 v3, s[8:11], s40 offen offset:2048 lds
    v_mfma_f32_16x16x32_bf16 a[76:79], v[104:107], v[52:55], a[76:79]
    buffer_load_dwordx4 v[52:55], v2, s[12:15], s35 offen offset:3072
    v_mfma_f32_16x16x32_bf16 a[80:83], v[88:91], v[56:59], a[80:83]
    v_mfma_f32_16x16x32_bf16 a[84:87], v[92:95], v[56:59], a[84:87]
    ds_read_b128 v[84:87], v8 offset:14336
    v_mfma_f32_16x16x32_bf16 a[88:91], v[96:99], v[56:59], a[88:91]
    v_mfma_f32_16x16x32_bf16 a[92:95], v[100:103], v[56:59], a[92:95]
    s_add_u32 m0, s41, 0
    s_nop 0
    buffer_load_dwordx4 v3, s[8:11], s40 offen offset:3072 lds
    v_mfma_f32_16x16x32_bf16 a[96:99], v[104:107], v[56:59], a[96:99]
    buffer_load_dwordx4 v[56:59], v2, s[12:15], s36 offen offset:3072
    v_mfma_f32_16x16x32_bf16 a[100:103], v[88:91], v[60:63], a[100:103]
    v_mfma_f32_16x16x32_bf16 a[104:107], v[92:95], v[60:63], a[104:107]
    v_mfma_f32_16x16x32_bf16 a[108:111], v[96:99], v[60:63], a[108:111]
    v_mfma_f32_16x16x32_bf16 a[112:115], v[100:103], v[60:63], a[112:115]
    s_add_u32 s40, s40, 4096
    s_add_u32 m0, s41, 4096
    s_nop 0
    buffer_load_dwordx4 v3, s[8:11], s40 offen lds
    s_add_u32 s40, s40, 1024
    v_mfma_f32_16x16x32_bf16 a[116:119], v[104:107], v[60:63], a[116:119]
    buffer_load_dwordx4 v[60:63], v2, s[12:15], s37 offen offset:3072
    v_mfma_f32_16x16x32_bf16 a[120:123], v[88:91], v[64:67], a[120:123]
    v_mfma_f32_16x16x32_bf16 a[124:127], v[92:95], v[64:67], a[124:127]
    v_mfma_f32_16x16x32_bf16 a[128:131], v[96:99], v[64:67], a[128:131]
    v_mfma_f32_16x16x32_bf16 a[132:135], v[100:103], v[64:67], a[132:135]
    v_mfma_f32_16x16x32_bf16 a[136:139], v[104:107], v[64:67], a[136:139]
    buffer_load_dwordx4 v[64:67], v2, s[12:15], s38 offen offset:3072
    v_add_u32 v2, 4096, v2
    s_waitcnt vmcnt(12)
    s_waitcnt lgkmcnt(4)
    v_mfma_f32_16x16x32_bf16 a[0:3], v[68:71], v[12:15], a[0:3]
    s_waitcnt lgkmcnt(3)
    v_mfma_f32_16x16x32_bf16 a[4:7], v[72:75], v[12:15], a[4:7]
    ds_read_b128 v[88:91], v8 offset:15360
    s_waitcnt lgkmcnt(3)
    v_mfma_f32_16x16x32_bf16 a[8:11], v[76:79], v[12:15], a[8:11]
    s_waitcnt lgkmcnt(2)
    v_mfma_f32_16x16x32_bf16 a[12:15], v[80:83], v[12:15], a[12:15]
    s_waitcnt lgkmcnt(1)
    v_mfma_f32_16x16x32_bf16 a[16:19], v[84:87], v[12:15], a[16:19]
    buffer_load_dwordx4 v[12:15], v2, s[12:15], s32 offen
    v_mfma_f32_16x16x32_bf16 a[20:23], v[68:71], v[16:19], a[20:23]
    v_mfma_f32_16x16x32_bf16 a[24:27], v[72:75], v[16:19], a[24:27]
    ds_read_b128 v[92:95], v8 offset:16384
    v_mfma_f32_16x16x32_bf16 a[28:31], v[76:79], v[16:19], a[28:31]
    v_mfma_f32_16x16x32_bf16 a[32:35], v[80:83], v[16:19], a[32:35]
    s_add_u32 m0, s41, 5120
    s_nop 0
    buffer_load_dwordx4 v3, s[8:11], s40 offen lds
    v_mfma_f32_16x16x32_bf16 a[36:39], v[84:87], v[16:19], a[36:39]
    buffer_load_dwordx4 v[16:19], v2, s[12:15], s33 offen
    v_mfma_f32_16x16x32_bf16 a[40:43], v[68:71], v[20:23], a[40:43]
    v_mfma_f32_16x16x32_bf16 a[44:47], v[72:75], v[20:23], a[44:47]
    ds_read_b128 v[96:99], v8 offset:17408
    v_mfma_f32_16x16x32_bf16 a[48:51], v[76:79], v[20:23], a[48:51]
    v_mfma_f32_16x16x32_bf16 a[52:55], v[80:83], v[20:23], a[52:55]
    s_add_u32 m0, s41, 5120
    s_nop 0
    buffer_load_dwordx4 v3, s[8:11], s40 offen offset:1024 lds
    v_mfma_f32_16x16x32_bf16 a[56:59], v[84:87], v[20:23], a[56:59]
    buffer_load_dwordx4 v[20:23], v2, s[12:15], s34 offen
    v_mfma_f32_16x16x32_bf16 a[60:63], v[68:71], v[24:27], a[60:63]
    v_mfma_f32_16x16x32_bf16 a[64:67], v[72:75], v[24:27], a[64:67]
    ds_read_b128 v[100:103], v8 offset:18432
    v_mfma_f32_16x16x32_bf16 a[68:71], v[76:79], v[24:27], a[68:71]
    v_mfma_f32_16x16x32_bf16 a[72:75], v[80:83], v[24:27], a[72:75]
    s_add_u32 m0, s41, 5120
    s_nop 0
    buffer_load_dwordx4 v3, s[8:11], s40 offen offset:2048 lds
    v_mfma_f32_16x16x32_bf16 a[76:79], v[84:87], v[24:27], a[76:79]
    buffer_load_dwordx4 v[24:27], v2, s[12:15], s35 offen
    v_mfma_f32_16x16x32_bf16 a[80:83], v[68:71], v[28:31], a[80:83]
    v_mfma_f32_16x16x32_bf16 a[84:87], v[72:75], v[28:31], a[84:87]
    ds_read_b128 v[104:107], v8 offset:19456
    v_mfma_f32_16x16x32_bf16 a[88:91], v[76:79], v[28:31], a[88:91]
    v_mfma_f32_16x16x32_bf16 a[92:95], v[80:83], v[28:31], a[92:95]
    s_add_u32 m0, s41, 5120
    s_nop 0
    buffer_load_dwordx4 v3, s[8:11], s40 offen offset:3072 lds
    v_mfma_f32_16x16x32_bf16 a[96:99], v[84:87], v[28:31], a[96:99]
    buffer_load_dwordx4 v[28:31], v2, s[12:15], s36 offen
    v_mfma_f32_16x16x32_bf16 a[100:103], v[68:71], v[32:35], a[100:103]
    v_mfma_f32_16x16x32_bf16 a[104:107], v[72:75], v[32:35], a[104:107]
    v_mfma_f32_16x16x32_bf16 a[108:111], v[76:79], v[32:35], a[108:111]
    v_mfma_f32_16x16x32_bf16 a[112:115], v[80:83], v[32:35], a[112:115]
    s_add_u32 s40, s40, 4096
    s_add_u32 m0, s41, 9216
    s_nop 0
    buffer_load_dwordx4 v3, s[8:11], s40 offen lds
    s_add_u32 s40, s40, 1024
    v_mfma_f32_16x16x32_bf16 a[116:119], v[84:87], v[32:35], a[116:119]
    buffer_load_dwordx4 v[32:35], v2, s[12:15], s37 offen
    v_mfma_f32_16x16x32_bf16 a[120:123], v[68:71], v[36:39], a[120:123]
    v_mfma_f32_16x16x32_bf16 a[124:127], v[72:75], v[36:39], a[124:127]
    v_mfma_f32_16x16x32_bf16 a[128:131], v[76:79], v[36:39], a[128:131]
    v_mfma_f32_16x16x32_bf16 a[132:135], v[80:83], v[36:39], a[132:135]
    v_mfma_f32_16x16x32_bf16 a[136:139], v[84:87], v[36:39], a[136:139]
    buffer_load_dwordx4 v[36:39], v2, s[12:15], s38 offen
    s_waitcnt vmcnt(12)
    s_waitcnt lgkmcnt(4)
    v_mfma_f32_16x16x32_bf16 a[0:3], v[88:91], v[40:43], a[0:3]
    s_waitcnt lgkmcnt(3)
    v_mfma_f32_16x16x32_bf16 a[4:7], v[92:95], v[40:43], a[4:7]
    ds_read_b128 v[68:71], v8 offset:0
    s_waitcnt lgkmcnt(3)
    v_mfma_f32_16x16x32_bf16 a[8:11], v[96:99], v[40:43], a[8:11]
    s_waitcnt lgkmcnt(2)
    v_mfma_f32_16x16x32_bf16 a[12:15], v[100:103], v[40:43], a[12:15]
    s_waitcnt lgkmcnt(1)
    v_mfma_f32_16x16x32_bf16 a[16:19], v[104:107], v[40:43], a[16:19]
    buffer_load_dwordx4 v[40:43], v2, s[12:15], s32 offen offset:1024
    v_mfma_f32_16x16x32_bf16 a[20:23], v[88:91], v[44:47], a[20:23]
    v_mfma_f32_16x16x32_bf16 a[24:27], v[92:95], v[44:47], a[24:27]
    ds_read_b128 v[72:75], v8 offset:1024
    v_mfma_f32_16x16x32_bf16 a[28:31], v[96:99], v[44:47], a[28:31]
    v_mfma_f32_16x16x32_bf16 a[32:35], v[100:103], v[44:47], a[32:35]
    s_add_u32 m0, s41, 10240
    s_nop 0
    buffer_load_dwordx4 v3, s[8:11], s40 offen lds
    v_mfma_f32_16x16x32_bf16 a[36:39], v[104:107], v[44:47], a[36:39]
    buffer_load_dwordx4 v[44:47], v2, s[12:15], s33 offen offset:1024
    v_mfma_f32_16x16x32_bf16 a[40:43], v[88:91], v[48:51], a[40:43]
    v_mfma_f32_16x16x32_bf16 a[44:47], v[92:95], v[48:51], a[44:47]
    ds_read_b128 v[76:79], v8 offset:2048
    v_mfma_f32_16x16x32_bf16 a[48:51], v[96:99], v[48:51], a[48:51]
    v_mfma_f32_16x16x32_bf16 a[52:55], v[100:103], v[48:51], a[52:55]
    s_add_u32 m0, s41, 10240
    s_nop 0
    buffer_load_dwordx4 v3, s[8:11], s40 offen offset:1024 lds
    v_mfma_f32_16x16x32_bf16 a[56:59], v[104:107], v[48:51], a[56:59]
    buffer_load_dwordx4 v[48:51], v2, s[12:15], s34 offen offset:1024
    v_mfma_f32_16x16x32_bf16 a[60:63], v[88:91], v[52:55], a[60:63]
    v_mfma_f32_16x16x32_bf16 a[64:67], v[92:95], v[52:55], a[64:67]
    ds_read_b128 v[80:83], v8 offset:3072
    v_mfma_f32_16x16x32_bf16 a[68:71], v[96:99], v[52:55], a[68:71]
    v_mfma_f32_16x16x32_bf16 a[72:75], v[100:103], v[52:55], a[72:75]
    s_add_u32 m0, s41, 10240
    s_nop 0
    buffer_load_dwordx4 v3, s[8:11], s40 offen offset:2048 lds
    v_mfma_f32_16x16x32_bf16 a[76:79], v[104:107], v[52:55], a[76:79]
    buffer_load_dwordx4 v[52:55], v2, s[12:15], s35 offen offset:1024
    v_mfma_f32_16x16x32_bf16 a[80:83], v[88:91], v[56:59], a[80:83]
    v_mfma_f32_16x16x32_bf16 a[84:87], v[92:95], v[56:59], a[84:87]
    ds_read_b128 v[84:87], v8 offset:4096
    v_mfma_f32_16x16x32_bf16 a[88:91], v[96:99], v[56:59], a[88:91]
    v_mfma_f32_16x16x32_bf16 a[92:95], v[100:103], v[56:59], a[92:95]
    s_add_u32 m0, s41, 10240
    s_nop 0
    buffer_load_dwordx4 v3, s[8:11], s40 offen offset:3072 lds
    v_mfma_f32_16x16x32_bf16 a[96:99], v[104:107], v[56:59], a[96:99]
    buffer_load_dwordx4 v[56:59], v2, s[12:15], s36 offen offset:1024
    v_mfma_f32_16x16x32_bf16 a[100:103], v[88:91], v[60:63], a[100:103]
    v_mfma_f32_16x16x32_bf16 a[104:107], v[92:95], v[60:63], a[104:107]
    v_mfma_f32_16x16x32_bf16 a[108:111], v[96:99], v[60:63], a[108:111]
    v_mfma_f32_16x16x32_bf16 a[112:115], v[100:103], v[60:63], a[112:115]
    s_add_u32 s40, s40, 4096
    s_add_u32 m0, s41, 14336
    s_nop 0
    buffer_load_dwordx4 v3, s[8:11], s40 offen lds
    s_add_u32 s40, s40, 1024
    v_mfma_f32_16x16x32_bf16 a[116:119], v[104:107], v[60:63], a[116:119]
    buffer_load_dwordx4 v[60:63], v2, s[12:15], s37 offen offset:1024
    v_mfma_f32_16x16x32_bf16 a[120:123], v[88:91], v[64:67], a[120:123]
    v_mfma_f32_16x16x32_bf16 a[124:127], v[92:95], v[64:67], a[124:127]
    v_mfma_f32_16x16x32_bf16 a[128:131], v[96:99], v[64:67], a[128:131]
    v_mfma_f32_16x16x32_bf16 a[132:135], v[100:103], v[64:67], a[132:135]
    v_mfma_f32_16x16x32_bf16 a[136:139], v[104:107], v[64:67], a[136:139]
    buffer_load_dwordx4 v[64:67], v2, s[12:15], s38 offen offset:1024
    s_add_u32 s42, s42, 1
    s_cmp_lt_u32 s42, 3
    s_cbranch_scc1 L_k2_loop
    s_waitcnt vmcnt(12)
    s_waitcnt lgkmcnt(4)
    v_mfma_f32_16x16x32_bf16 a[0:3], v[68:71], v[12:15], a[0:3]
    s_waitcnt lgkmcnt(3)
    v_mfma_f32_16x16x32_bf16 a[4:7], v[72:75], v[12:15], a[4:7]
    ds_read_b128 v[88:91], v8 offset:5120
    s_waitcnt lgkmcnt(3)
    v_mfma_f32_16x16x32_bf16 a[8:11], v[76:79], v[12:15], a[8:11]
    s_waitcnt lgkmcnt(2)
    v_mfma_f32_16x16x32_bf16 a[12:15], v[80:83], v[12:15], a[12:15]
    s_waitcnt lgkmcnt(1)
    v_mfma_f32_16x16x32_bf16 a[16:19], v[84:87], v[12:15], a[16:19]
    buffer_load_dwordx4 v[12:15], v2, s[12:15], s32 offen offset:2048
    v_mfma_f32_16x16x32_bf16 a[20:23], v[68:71], v[16:19], a[20:23]
    v_mfma_f32_16x16x32_bf16 a[24:27], v[72:75], v[16:19], a[24:27]
    ds_read_b128 v[92:95], v8 offset:6144
    v_mfma_f32_16x16x32_bf16 a[28:31], v[76:79], v[16:19], a[28:31]
    v_mfma_f32_16x16x32_bf16 a[32:35], v[80:83], v[16:19], a[32:35]
    s_add_u32 m0, s41, 15360
    s_nop 0
    buffer_load_dwordx4 v3, s[8:11], s40 offen lds
    v_mfma_f32_16x16x32_bf16 a[36:39], v[84:87], v[16:19], a[36:39]
    buffer_load_dwordx4 v[16:19], v2, s[12:15], s33 offen offset:2048
    v_mfma_f32_16x16x32_bf16 a[40:43], v[68:71], v[20:23], a[40:43]
    v_mfma_f32_16x16x32_bf16 a[44:47], v[72:75], v[20:23], a[44:47]
    ds_read_b128 v[96:99], v8 offset:7168
    v_mfma_f32_16x16x32_bf16 a[48:51], v[76:79], v[20:23], a[48:51]
    v_mfma_f32_16x16x32_bf16 a[52:55], v[80:83], v[20:23], a[52:55]
    s_add_u32 m0, s41, 15360
    s_nop 0
    buffer_load_dwordx4 v3, s[8:11], s40 offen offset:1024 lds
    v_mfma_f32_16x16x32_bf16 a[56:59], v[84:87], v[20:23], a[56:59]
    buffer_load_dwordx4 v[20:23], v2, s[12:15], s34 offen offset:2048
    v_mfma_f32_16x16x32_bf16 a[60:63], v[68:71], v[24:27], a[60:63]
    v_mfma_f32_16x16x32_bf16 a[64:67], v[72:75], v[24:27], a[64:67]
    ds_read_b128 v[100:103], v8 offset:8192
    v_mfma_f32_16x16x32_bf16 a[68:71], v[76:79], v[24:27], a[68:71]
    v_mfma_f32_16x16x32_bf16 a[72:75], v[80:83], v[24:27], a[72:75]
    s_add_u32 m0, s41, 15360
    s_nop 0
    buffer_load_dwordx4 v3, s[8:11], s40 offen offset:2048 lds
    v_mfma_f32_16x16x32_bf16 a[76:79], v[84:87], v[24:27], a[76:79]
    buffer_load_dwordx4 v[24:27], v2, s[12:15], s35 offen offset:2048
    v_mfma_f32_16x16x32_bf16 a[80:83], v[68:71], v[28:31], a[80:83]
    v_mfma_f32_16x16x32_bf16 a[84:87], v[72:75], v[28:31], a[84:87]
    ds_read_b128 v[104:107], v8 offset:9216
    v_mfma_f32_16x16x32_bf16 a[88:91], v[76:79], v[28:31], a[88:91]
    v_mfma_f32_16x16x32_bf16 a[92:95], v[80:83], v[28:31], a[92:95]
    s_add_u32 m0, s41, 15360
    s_nop 0
    buffer_load_dwordx4 v3, s[8:11], s40 offen offset:3072 lds
    v_mfma_f32_16x16x32_bf16 a[96:99], v[84:87], v[28:31], a[96:99]
    buffer_load_dwordx4 v[28:31], v2, s[12:15], s36 offen offset:2048
    v_mfma_f32_16x16x32_bf16 a[100:103], v[68:71], v[32:35], a[100:103]
    v_mfma_f32_16x16x32_bf16 a[104:107], v[72:75], v[32:35], a[104:107]
    v_mfma_f32_16x16x32_bf16 a[108:111], v[76:79], v[32:35], a[108:111]
    v_mfma_f32_16x16x32_bf16 a[112:115], v[80:83], v[32:35], a[112:115]
    s_add_u32 s40, s40, 4096
    s_add_u32 m0, s41, 19456
    s_nop 0
    buffer_load_dwordx4 v3, s[8:11], s40 offen lds
    s_add_u32 s40, s40, 1024
    v_mfma_f32_16x16x32_bf16 a[116:119], v[84:87], v[32:35], a[116:119]
    buffer_load_dwordx4 v[32:35], v2, s[12:15], s37 offen offset:2048
    v_mfma_f32_16x16x32_bf16 a[120:123], v[68:71], v[36:39], a[120:123]
    v_mfma_f32_16x16x32_bf16 a[124:127], v[72:75], v[36:39], a[124:127]
    v_mfma_f32_16x16x32_bf16 a[128:131], v[76:79], v[36:39], a[128:131]
    v_mfma_f32_16x16x32_bf16 a[132:135], v[80:83], v[36:39], a[132:135]
    v_mfma_f32_16x16x32_bf16 a[136:139], v[84:87], v[36:39], a[136:139]
    buffer_load_dwordx4 v[36:39], v2, s[12:15], s38 offen offset:2048
    s_waitcnt vmcnt(12)
    s_waitcnt lgkmcnt(4)
    v_mfma_f32_16x16x32_bf16 a[0:3], v[88:91], v[40:43], a[0:3]
    s_waitcnt lgkmcnt(3)
    v_mfma_f32_16x16x32_bf16 a[4:7], v[92:95], v[40:43], a[4:7]
    ds_read_b128 v[68:71], v8 offset:10240
    s_waitcnt lgkmcnt(3)
    v_mfma_f32_16x16x32_bf16 a[8:11], v[96:99], v[40:43], a[8:11]
    s_waitcnt lgkmcnt(2)
    v_mfma_f32_16x16x32_bf16 a[12:15], v[100:103], v[40:43], a[12:15]
    s_waitcnt lgkmcnt(1)
    v_mfma_f32_16x16x32_bf16 a[16:19], v[104:107], v[40:43], a[16:19]
    buffer_load_dwordx4 v[40:43], v2, s[12:15], s32 offen offset:3072
    v_mfma_f32_16x16x32_bf16 a[20:23], v[88:91], v[44:47], a[20:23]
    v_mfma_f32_16x16x32_bf16 a[24:27], v[92:95], v[44:47], a[24:27]
    ds_read_b128 v[72:75], v8 offset:11264
    v_mfma_f32_16x16x32_bf16 a[28:31], v[96:99], v[44:47], a[28:31]
    v_mfma_f32_16x16x32_bf16 a[32:35], v[100:103], v[44:47], a[32:35]
    v_mfma_f32_16x16x32_bf16 a[36:39], v[104:107], v[44:47], a[36:39]
    buffer_load_dwordx4 v[44:47], v2, s[12:15], s33 offen offset:3072
    v_mfma_f32_16x16x32_bf16 a[40:43], v[88:91], v[48:51], a[40:43]
    v_mfma_f32_16x16x32_bf16 a[44:47], v[92:95], v[48:51], a[44:47]
    ds_read_b128 v[76:79], v8 offset:12288
    v_mfma_f32_16x16x32_bf16 a[48:51], v[96:99], v[48:51], a[48:51]
    v_mfma_f32_16x16x32_bf16 a[52:55], v[100:103], v[48:51], a[52:55]
    v_mfma_f32_16x16x32_bf16 a[56:59], v[104:107], v[48:51], a[56:59]
    buffer_load_dwordx4 v[48:51], v2, s[12:15], s34 offen offset:3072
    v_mfma_f32_16x16x32_bf16 a[60:63], v[88:91], v[52:55], a[60:63]
    v_mfma_f32_16x16x32_bf16 a[64:67], v[92:95], v[52:55], a[64:67]
    ds_read_b128 v[80:83], v8 offset:13312
    v_mfma_f32_16x16x32_bf16 a[68:71], v[96:99], v[52:55], a[68:71]
    v_mfma_f32_16x16x32_bf16 a[72:75], v[100:103], v[52:55], a[72:75]
    v_mfma_f32_16x16x32_bf16 a[76:79], v[104:107], v[52:55], a[76:79]
    buffer_load_dwordx4 v[52:55], v2, s[12:15], s35 offen offset:3072
    v_mfma_f32_16x16x32_bf16 a[80:83], v[88:91], v[56:59], a[80:83]
    v_mfma_f32_16x16x32_bf16 a[84:87], v[92:95], v[56:59], a[84:87]
    ds_read_b128 v[84:87], v8 offset:14336
    v_mfma_f32_16x16x32_bf16 a[88:91], v[96:99], v[56:59], a[88:91]
    v_mfma_f32_16x16x32_bf16 a[92:95], v[100:103], v[56:59], a[92:95]
    v_mfma_f32_16x16x32_bf16 a[96:99], v[104:107], v[56:59], a[96:99]
    buffer_load_dwordx4 v[56:59], v2, s[12:15], s36 offen offset:3072
    v_mfma_f32_16x16x32_bf16 a[100:103], v[88:91], v[60:63], a[100:103]
    v_mfma_f32_16x16x32_bf16 a[104:107], v[92:95], v[60:63], a[104:107]
    v_mfma_f32_16x16x32_bf16 a[108:111], v[96:99], v[60:63], a[108:111]
    v_mfma_f32_16x16x32_bf16 a[112:115], v[100:103], v[60:63], a[112:115]
    v_mfma_f32_16x16x32_bf16 a[116:119], v[104:107], v[60:63], a[116:119]
    buffer_load_dwordx4 v[60:63], v2, s[12:15], s37 offen offset:3072
    v_mfma_f32_16x16x32_bf16 a[120:123], v[88:91], v[64:67], a[120:123]
    v_mfma_f32_16x16x32_bf16 a[124:127], v[92:95], v[64:67], a[124:127]
    v_mfma_f32_16x16x32_bf16 a[128:131], v[96:99], v[64:67], a[128:131]
    v_mfma_f32_16x16x32_bf16 a[132:135], v[100:103], v[64:67], a[132:135]
    v_mfma_f32_16x16x32_bf16 a[136:139], v[104:107], v[64:67], a[136:139]
    buffer_load_dwordx4 v[64:67], v2, s[12:15], s38 offen offset:3072
    v_add_u32 v2, 4096, v2
    s_waitcnt vmcnt(7)
    s_waitcnt lgkmcnt(4)
    v_mfma_f32_16x16x32_bf16 a[0:3], v[68:71], v[12:15], a[0:3]
    s_waitcnt lgkmcnt(3)
    v_mfma_f32_16x16x32_bf16 a[4:7], v[72:75], v[12:15], a[4:7]
    ds_read_b128 v[88:91], v8 offset:15360
    s_waitcnt lgkmcnt(3)
    v_mfma_f32_16x16x32_bf16 a[8:11], v[76:79], v[12:15], a[8:11]
    s_waitcnt lgkmcnt(2)
    v_mfma_f32_16x16x32_bf16 a[12:15], v[80:83], v[12:15], a[12:15]
    s_waitcnt lgkmcnt(1)
    v_mfma_f32_16x16x32_bf16 a[16:19], v[84:87], v[12:15], a[16:19]
    v_mfma_f32_16x16x32_bf16 a[20:23], v[68:71], v[16:19], a[20:23]
    v_mfma_f32_16x16x32_bf16 a[24:27], v[72:75], v[16:19], a[24:27]
    ds_read_b128 v[92:95], v8 offset:16384
    v_mfma_f32_16x16x32_bf16 a[28:31], v[76:79], v[16:19], a[28:31]
    v_mfma_f32_16x16x32_bf16 a[32:35], v[80:83], v[16:19], a[32:35]
    v_mfma_f32_16x16x32_bf16 a[36:39], v[84:87], v[16:19], a[36:39]
    v_mfma_f32_16x16x32_bf16 a[40:43], v[68:71], v[20:23], a[40:43]
    v_mfma_f32_16x16x32_bf16 a[44:47], v[72:75], v[20:23], a[44:47]
    ds_read_b128 v[96:99], v8 offset:17408
    v_mfma_f32_16x16x32_bf16 a[48:51], v[76:79], v[20:23], a[48:51]
    v_mfma_f32_16x16x32_bf16 a[52:55], v[80:83], v[20:23], a[52:55]
    v_mfma_f32_16x16x32_bf16 a[56:59], v[84:87], v[20:23], a[56:59]
    v_mfma_f32_16x16x32_bf16 a[60:63], v[68:71], v[24:27], a[60:63]
    v_mfma_f32_16x16x32_bf16 a[64:67], v[72:75], v[24:27], a[64:67]
    ds_read_b128 v[100:103], v8 offset:18432
    v_mfma_f32_16x16x32_bf16 a[68:71], v[76:79], v[24:27], a[68:71]
    v_mfma_f32_16x16x32_bf16 a[72:75], v[80:83], v[24:27], a[72:75]
    v_mfma_f32_16x16x32_bf16 a[76:79], v[84:87], v[24:27], a[76:79]
    v_mfma_f32_16x16x32_bf16 a[80:83], v[68:71], v[28:31], a[80:83]
    v_mfma_f32_16x16x32_bf16 a[84:87], v[72:75], v[28:31], a[84:87]
    ds_read_b128 v[104:107], v8 offset:19456
    v_mfma_f32_16x16x32_bf16 a[88:91], v[76:79], v[28:31], a[88:91]
    v_mfma_f32_16x16x32_bf16 a[92:95], v[80:83], v[28:31], a[92:95]
    v_mfma_f32_16x16x32_bf16 a[96:99], v[84:87], v[28:31], a[96:99]
    v_mfma_f32_16x16x32_bf16 a[100:103], v[68:71], v[32:35], a[100:103]
    v_mfma_f32_16x16x32_bf16 a[104:107], v[72:75], v[32:35], a[104:107]
    v_mfma_f32_16x16x32_bf16 a[108:111], v[76:79], v[32:35], a[108:111]
    v_mfma_f32_16x16x32_bf16 a[112:115], v[80:83], v[32:35], a[112:115]
    v_mfma_f32_16x16x32_bf16 a[116:119], v[84:87], v[32:35], a[116:119]
    v_mfma_f32_16x16x32_bf16 a[120:123], v[68:71], v[36:39], a[120:123]
    v_mfma_f32_16x16x32_bf16 a[124:127], v[72:75], v[36:39], a[124:127]
    v_mfma_f32_16x16x32_bf16 a[128:131], v[76:79], v[36:39], a[128:131]
    v_mfma_f32_16x16x32_bf16 a[132:135], v[80:83], v[36:39], a[132:135]
    v_mfma_f32_16x16x32_bf16 a[136:139], v[84:87], v[36:39], a[136:139]
    s_waitcnt vmcnt(0)
    s_waitcnt lgkmcnt(4)
    v_mfma_f32_16x16x32_bf16 a[0:3], v[88:91], v[40:43], a[0:3]
    s_waitcnt lgkmcnt(3)
    v_mfma_f32_16x16x32_bf16 a[4:7], v[92:95], v[40:43], a[4:7]
    s_waitcnt lgkmcnt(2)
    v_mfma_f32_16x16x32_bf16 a[8:11], v[96:99], v[40:43], a[8:11]
    s_waitcnt lgkmcnt(1)
    v_mfma_f32_16x16x32_bf16 a[12:15], v[100:103], v[40:43], a[12:15]
    s_waitcnt lgkmcnt(0)
    v_mfma_f32_16x16x32_bf16 a[16:19], v[104:107], v[40:43], a[16:19]
    v_mfma_f32_16x16x32_bf16 a[20:23], v[88:91], v[44:47], a[20:23]
    v_mfma_f32_16x16x32_bf16 a[24:27], v[92:95], v[44:47], a[24:27]
    v_mfma_f32_16x16x32_bf16 a[28:31], v[96:99], v[44:47], a[28:31]
    v_mfma_f32_16x16x32_bf16 a[32:35], v[100:103], v[44:47], a[32:35]
    v_mfma_f32_16x16x32_bf16 a[36:39], v[104:107], v[44:47], a[36:39]
    v_mfma_f32_16x16x32_bf16 a[40:43], v[88:91], v[48:51], a[40:43]
    v_mfma_f32_16x16x32_bf16 a[44:47], v[92:95], v[48:51], a[44:47]
    v_mfma_f32_16x16x32_bf16 a[48:51], v[96:99], v[48:51], a[48:51]
    v_mfma_f32_16x16x32_bf16 a[52:55], v[100:103], v[48:51], a[52:55]
    v_mfma_f32_16x16x32_bf16 a[56:59], v[104:107], v[48:51], a[56:59]
    v_mfma_f32_16x16x32_bf16 a[60:63], v[88:91], v[52:55], a[60:63]
    v_mfma_f32_16x16x32_bf16 a[64:67], v[92:95], v[52:55], a[64:67]
    v_mfma_f32_16x16x32_bf16 a[68:71], v[96:99], v[52:55], a[68:71]
    v_mfma_f32_16x16x32_bf16 a[72:75], v[100:103], v[52:55], a[72:75]
    v_mfma_f32_16x16x32_bf16 a[76:79], v[104:107], v[52:55], a[76:79]
    v_mfma_f32_16x16x32_bf16 a[80:83], v[88:91], v[56:59], a[80:83]
    v_mfma_f32_16x16x32_bf16 a[84:87], v[92:95], v[56:59], a[84:87]
    v_mfma_f32_16x16x32_bf16 a[88:91], v[96:99], v[56:59], a[88:91]
    v_mfma_f32_16x16x32_bf16 a[92:95], v[100:103], v[56:59], a[92:95]
    v_mfma_f32_16x16x32_bf16 a[96:99], v[104:107], v[56:59], a[96:99]
    v_mfma_f32_16x16x32_bf16 a[100:103], v[88:91], v[60:63], a[100:103]
    v_mfma_f32_16x16x32_bf16 a[104:107], v[92:95], v[60:63], a[104:107]
    v_mfma_f32_16x16x32_bf16 a[108:111], v[96:99], v[60:63], a[108:111]
    v_mfma_f32_16x16x32_bf16 a[112:115], v[100:103], v[60:63], a[112:115]
    v_mfma_f32_16x16x32_bf16 a[116:119], v[104:107], v[60:63], a[116:119]
    v_mfma_f32_16x16x32_bf16 a[120:123], v[88:91], v[64:67], a[120:123]
    v_mfma_f32_16x16x32_bf16 a[124:127], v[92:95], v[64:67], a[124:127]
    v_mfma_f32_16x16x32_bf16 a[128:131], v[96:99], v[64:67], a[128:131]
    v_mfma_f32_16x16x32_bf16 a[132:135], v[100:103], v[64:67], a[132:135]
    v_mfma_f32_16x16x32_bf16 a[136:139], v[104:107], v[64:67], a[136:139]
    s_nop 9
    s_waitcnt vmcnt(0)
    s_waitcnt lgkmcnt(0)
    s_barrier
    v_and_b32 v10, 15, v0
    v_mul_u32_u24 v10, 336, v10
    v_lshrrev_b32 v11, 4, v0
    v_lshl_add_u32 v10, v11, 4, v10
    s_and_b32 s3, s28, 3
    s_mul_i32 s3, s3, 37632
    v_add_u32 v10, s3, v10
    s_cmp_lt_u32 s28, 4
    s_cbranch_scc1 L_k2_lo1
    ds_write_b128 v10, a[0:3] offset:0
    ds_write_b128 v10, a[4:7] offset:64
    ds_write_b128 v10, a[8:11] offset:128
    ds_write_b128 v10, a[12:15] offset:192
    ds_write_b128 v10, a[16:19] offset:256
    ds_write_b128 v10, a[20:23] offset:5376
    ds_write_b128 v10, a[24:27] offset:5440
    ds_write_b128 v10, a[28:31] offset:5504
    ds_write_b128 v10, a[32:35] offset:5568
    ds_write_b128 v10, a[36:39] offset:5632
    ds_write_b128 v10, a[40:43] offset:10752
    ds_write_b128 v10, a[44:47] offset:10816
    ds_write_b128 v10, a[48:51] offset:10880
    ds_write_b128 v10, a[52:55] offset:10944
    ds_write_b128 v10, a[56:59] offset:11008
    ds_write_b128 v10, a[60:63] offset:16128
    ds_write_b128 v10, a[64:67] offset:16192
    ds_write_b128 v10, a[68:71] offset:16256
    ds_write_b128 v10, a[72:75] offset:16320
    ds_write_b128 v10, a[76:79] offset:16384
    ds_write_b128 v10, a[80:83] offset:21504
    ds_write_b128 v10, a[84:87] offset:21568
    ds_write_b128 v10, a[88:91] offset:21632
    ds_write_b128 v10, a[92:95] offset:21696
    ds_write_b128 v10, a[96:99] offset:21760
    ds_write_b128 v10, a[100:103] offset:26880
    ds_write_b128 v10, a[104:107] offset:26944
    ds_write_b128 v10, a[108:111] offset:27008
    ds_write_b128 v10, a[112:115] offset:27072
    ds_write_b128 v10, a[116:119] offset:27136
    ds_write_b128 v10, a[120:123] offset:32256
    ds_write_b128 v10, a[124:127] offset:32320
    ds_write_b128 v10, a[128:131] offset:32384
    ds_write_b128 v10, a[132:135] offset:32448
    ds_write_b128 v10, a[136:139] offset:32512
    s_waitcnt lgkmcnt(0)
L_k2_lo1:
    s_barrier
    s_cmp_ge_u32 s28, 4
    s_cbranch_scc1 L_k2_hi2
    ds_read_b128 v[12:15], v10 offset:0
    ds_read_b128 v[16:19], v10 offset:64
    ds_read_b128 v[20:23], v10 offset:128
    ds_read_b128 v[24:27], v10 offset:192
    ds_read_b128 v[28:31], v10 offset:256
    ds_read_b128 v[32:35], v10 offset:5376
    ds_read_b128 v[36:39], v10 offset:5440
    v_accvgpr_read_b32 v40, a0
    v_accvgpr_read_b32 v41, a1
    v_accvgpr_read_b32 v42, a2
    v_accvgpr_read_b32 v43, a3
    v_accvgpr_read_b32 v44, a4
    v_accvgpr_read_b32 v45, a5
    v_accvgpr_read_b32 v46, a6
    v_accvgpr_read_b32 v47, a7
    v_accvgpr_read_b32 v48, a8
    v_accvgpr_read_b32 v49, a9
    v_accvgpr_read_b32 v50, a10
    v_accvgpr_read_b32 v51, a11
    v_accvgpr_read_b32 v52, a12
    v_accvgpr_read_b32 v53, a13
    v_accvgpr_read_b32 v54, a14
    v_accvgpr_read_b32 v55, a15
    v_accvgpr_read_b32 v56, a16
    v_accvgpr_read_b32 v57, a17
    v_accvgpr_read_b32 v58, a18
    v_accvgpr_read_b32 v59, a19
    v_accvgpr_read_b32 v60, a20
    v_accvgpr_read_b32 v61, a21
    v_accvgpr_read_b32 v62, a22
    v_accvgpr_read_b32 v63, a23
    v_accvgpr_read_b32 v64, a24
    v_accvgpr_read_b32 v65, a25
    v_accvgpr_read_b32 v66, a26
    v_accvgpr_read_b32 v67, a27
    s_waitcnt lgkmcnt(6)
    v_add_f32 v40, v40, v12
    v_add_f32 v41, v41, v13
    v_add_f32 v42, v42, v14
    v_add_f32 v43, v43, v15
    ds_write_b128 v10, v[40:43] offset:0
    s_waitcnt lgkmcnt(6)
    v_add_f32 v44, v44, v16
    v_add_f32 v45, v45, v17
    v_add_f32 v46, v46, v18
    v_add_f32 v47, v47, v19
    ds_write_b128 v10, v[44:47] offset:64
    s_waitcnt lgkmcnt(6)
    v_add_f32 v48, v48, v20
    v_add_f32 v49, v49, v21
    v_add_f32 v50, v50, v22
    v_add_f32 v51, v51, v23
    ds_write_b128 v10, v[48:51] offset:128
    s_waitcnt lgkmcnt(6)
    v_add_f32 v52, v52, v24
    v_add_f32 v53, v53, v25
    v_add_f32 v54, v54, v26
    v_add_f32 v55, v55, v27
    ds_write_b128 v10, v[52:55] offset:192
    s_waitcnt lgkmcnt(6)
    v_add_f32 v56, v56, v28
    v_add_f32 v57, v57, v29
    v_add_f32 v58, v58, v30
    v_add_f32 v59, v59, v31
    ds_write_b128 v10, v[56:59] offset:256
    s_waitcnt lgkmcnt(6)
    v_add_f32 v60, v60, v32
    v_add_f32 v61, v61, v33
    v_add_f32 v62, v62, v34
    v_add_f32 v63, v63, v35
    ds_write_b128 v10, v[60:63] offset:5376
    s_waitcnt lgkmcnt(6)
    v_add_f32 v64, v64, v36
    v_add_f32 v65, v65, v37
    v_add_f32 v66, v66, v38
    v_add_f32 v67, v67, v39
    ds_write_b128 v10, v[64:67] offset:5440
    s_waitcnt lgkmcnt(0)
    ds_read_b128 v[12:15], v10 offset:5504
    ds_read_b128 v[16:19], v10 offset:5568
    ds_read_b128 v[20:23], v10 offset:5632
    ds_read_b128 v[24:27], v10 offset:10752
    ds_read_b128 v[28:31], v10 offset:10816
    ds_read_b128 v[32:35], v10 offset:10880
    ds_read_b128 v[36:39], v10 offset:10944
    v_accvgpr_read_b32 v40, a28
    v_accvgpr_read_b32 v41, a29
    v_accvgpr_read_b32 v42, a30
    v_accvgpr_read_b32 v43, a31
    v_accvgpr_read_b32 v44, a32
    v_accvgpr_read_b32 v45, a33
    v_accvgpr_read_b32 v46, a34
    v_accvgpr_read_b32 v47, a35
    v_accvgpr_read_b32 v48, a36
    v_accvgpr_read_b32 v49, a37
    v_accvgpr_read_b32 v50, a38
    v_accvgpr_read_b32 v51, a39
    v_accvgpr_read_b32 v52, a40
    v_accvgpr_read_b32 v53, a41
    v_accvgpr_read_b32 v54, a42
    v_accvgpr_read_b32 v55, a43
    v_accvgpr_read_b32 v56, a44
    v_accvgpr_read_b32 v57, a45
    v_accvgpr_read_b32 v58, a46
    v_accvgpr_read_b32 v59, a47
    v_accvgpr_read_b32 v60, a48
    v_accvgpr_read_b32 v61, a49
    v_accvgpr_read_b32 v62, a50
    v_accvgpr_read_b32 v63, a51
    v_accvgpr_read_b32 v64, a52
    v_accvgpr_read_b32 v65, a53
    v_accvgpr_read_b32 v66, a54
    v_accvgpr_read_b32 v67, a55
    s_waitcnt lgkmcnt(6)
    v_add_f32 v40, v40, v12
    v_add_f32 v41, v41, v13
    v_add_f32 v42, v42, v14
    v_add_f32 v43, v43, v15
    ds_write_b128 v10, v[40:43] offset:5504
    s_waitcnt lgkmcnt(6)
    v_add_f32 v44, v44, v16
    v_add_f32 v45, v45, v17
    v_add_f32 v46, v46, v18
    v_add_f32 v47, v47, v19
    ds_write_b128 v10, v[44:47] offset:5568
    s_waitcnt lgkmcnt(6)
    v_add_f32 v48, v48, v20
    v_add_f32 v49, v49, v21
    v_add_f32 v50, v50, v22
    v_add_f32 v51, v51, v23
    ds_write_b128 v10, v[48:51] offset:5632
    s_waitcnt lgkmcnt(6)
    v_add_f32 v52, v52, v24
    v_add_f32 v53, v53, v25
    v_add_f32 v54, v54, v26
    v_add_f32 v55, v55, v27
    ds_write_b128 v10, v[52:55] offset:10752
    s_waitcnt lgkmcnt(6)
    v_add_f32 v56, v56, v28
    v_add_f32 v57, v57, v29
    v_add_f32 v58, v58, v30
    v_add_f32 v59, v59, v31
    ds_write_b128 v10, v[56:59] offset:10816
    s_waitcnt lgkmcnt(6)
    v_add_f32 v60, v60, v32
    v_add_f32 v61, v61, v33
    v_add_f32 v62, v62, v34
    v_add_f32 v63, v63, v35
    ds_write_b128 v10, v[60:63] offset:10880
    s_waitcnt lgkmcnt(6)
    v_add_f32 v64, v64, v36
    v_add_f32 v65, v65, v37
    v_add_f32 v66, v66, v38
    v_add_f32 v67, v67, v39
    ds_write_b128 v10, v[64:67] offset:10944
    s_waitcnt lgkmcnt(0)
    ds_read_b128 v[12:15], v10 offset:11008
    ds_read_b128 v[16:19], v10 offset:16128
    ds_read_b128 v[20:23], v10 offset:16192
    ds_read_b128 v[24:27], v10 offset:16256
    ds_read_b128 v[28:31], v10 offset:16320
    ds_read_b128 v[32:35], v10 offset:16384
    ds_read_b128 v[36:39], v10 offset:21504
    v_accvgpr_read_b32 v40, a56
    v_accvgpr_read_b32 v41, a57
    v_accvgpr_read_b32 v42, a58
    v_accvgpr_read_b32 v43, a59
    v_accvgpr_read_b32 v44, a60
    v_accvgpr_read_b32 v45, a61
    v_accvgpr_read_b32 v46, a62
    v_accvgpr_read_b32 v47, a63
    v_accvgpr_read_b32 v48, a64
    v_accvgpr_read_b32 v49, a65
    v_accvgpr_read_b32 v50, a66
    v_accvgpr_read_b32 v51, a67
    v_accvgpr_read_b32 v52, a68
    v_accvgpr_read_b32 v53, a69
    v_accvgpr_read_b32 v54, a70
    v_accvgpr_read_b32 v55, a71
    v_accvgpr_read_b32 v56, a72
    v_accvgpr_read_b32 v57, a73
    v_accvgpr_read_b32 v58, a74
    v_accvgpr_read_b32 v59, a75
    v_accvgpr_read_b32 v60, a76
    v_accvgpr_read_b32 v61, a77
    v_accvgpr_read_b32 v62, a78
    v_accvgpr_read_b32 v63, a79
    v_accvgpr_read_b32 v64, a80
    v_accvgpr_read_b32 v65, a81
    v_accvgpr_read_b32 v66, a82
    v_accvgpr_read_b32 v67, a83
    s_waitcnt lgkmcnt(6)
    v_add_f32 v40, v40, v12
    v_add_f32 v41, v41, v13
    v_add_f32 v42, v42, v14
    v_add_f32 v43, v43, v15
    ds_write_b128 v10, v[40:43] offset:11008
    s_waitcnt lgkmcnt(6)
    v_add_f32 v44, v44, v16
    v_add_f32 v45, v45, v17
    v_add_f32 v46, v46, v18
    v_add_f32 v47, v47, v19
    ds_write_b128 v10, v[44:47] offset:16128
    s_waitcnt lgkmcnt(6)
    v_add_f32 v48, v48, v20
    v_add_f32 v49, v49, v21
    v_add_f32 v50, v50, v22
    v_add_f32 v51, v51, v23
    ds_write_b128 v10, v[48:51] offset:16192
    s_waitcnt lgkmcnt(6)
    v_add_f32 v52, v52, v24
    v_add_f32 v53, v53, v25
    v_add_f32 v54, v54, v26
    v_add_f32 v55, v55, v27
    ds_write_b128 v10, v[52:55] offset:16256
    s_waitcnt lgkmcnt(6)
    v_add_f32 v56, v56, v28
    v_add_f32 v57, v57, v29
    v_add_f32 v58, v58, v30
    v_add_f32 v59, v59, v31
    ds_write_b128 v10, v[56:59] offset:16320
    s_waitcnt lgkmcnt(6)
    v_add_f32 v60, v60, v32
    v_add_f32 v61, v61, v33
    v_add_f32 v62, v62, v34
    v_add_f32 v63, v63, v35
    ds_write_b128 v10, v[60:63] offset:16384
    s_waitcnt lgkmcnt(6)
    v_add_f32 v64, v64, v36
    v_add_f32 v65, v65, v37
    v_add_f32 v66, v66, v38
    v_add_f32 v67, v67, v39
    ds_write_b128 v10, v[64:67] offset:21504
    s_waitcnt lgkmcnt(0)
    ds_read_b128 v[12:15], v10 offset:21568
    ds_read_b128 v[16:19], v10 offset:21632
    ds_read_b128 v[20:23], v10 offset:21696
    ds_read_b128 v[24:27], v10 offset:21760
    ds_read_b128 v[28:31], v10 offset:26880
    ds_read_b128 v[32:35], v10 offset:26944
    ds_read_b128 v[36:39], v10 offset:27008
    v_accvgpr_read_b32 v40, a84
    v_accvgpr_read_b32 v41, a85
    v_accvgpr_read_b32 v42, a86
    v_accvgpr_read_b32 v43, a87
    v_accvgpr_read_b32 v44, a88
    v_accvgpr_read_b32 v45, a89
    v_accvgpr_read_b32 v46, a90
    v_accvgpr_read_b32 v47, a91
    v_accvgpr_read_b32 v48, a92
    v_accvgpr_read_b32 v49, a93
    v_accvgpr_read_b32 v50, a94
    v_accvgpr_read_b32 v51, a95
    v_accvgpr_read_b32 v52, a96
    v_accvgpr_read_b32 v53, a97
    v_accvgpr_read_b32 v54, a98
    v_accvgpr_read_b32 v55, a99
    v_accvgpr_read_b32 v56, a100
    v_accvgpr_read_b32 v57, a101
    v_accvgpr_read_b32 v58, a102
    v_accvgpr_read_b32 v59, a103
    v_accvgpr_read_b32 v60, a104
    v_accvgpr_read_b32 v61, a105
    v_accvgpr_read_b32 v62, a106
    v_accvgpr_read_b32 v63, a107
    v_accvgpr_read_b32 v64, a108
    v_accvgpr_read_b32 v65, a109
    v_accvgpr_read_b32 v66, a110
    v_accvgpr_read_b32 v67, a111
    s_waitcnt lgkmcnt(6)
    v_add_f32 v40, v40, v12
    v_add_f32 v41, v41, v13
    v_add_f32 v42, v42, v14
    v_add_f32 v43, v43, v15
    ds_write_b128 v10, v[40:43] offset:21568
    s_waitcnt lgkmcnt(6)
    v_add_f32 v44, v44, v16
    v_add_f32 v45, v45, v17
    v_add_f32 v46, v46, v18
    v_add_f32 v47, v47, v19
    ds_write_b128 v10, v[44:47] offset:21632
    s_waitcnt lgkmcnt(6)
    v_add_f32 v48, v48, v20
    v_add_f32 v49, v49, v21
    v_add_f32 v50, v50, v22
    v_add_f32 v51, v51, v23
    ds_write_b128 v10, v[48:51] offset:21696
    s_waitcnt lgkmcnt(6)
    v_add_f32 v52, v52, v24
    v_add_f32 v53, v53, v25
    v_add_f32 v54, v54, v26
    v_add_f32 v55, v55, v27
    ds_write_b128 v10, v[52:55] offset:21760
    s_waitcnt lgkmcnt(6)
    v_add_f32 v56, v56, v28
    v_add_f32 v57, v57, v29
    v_add_f32 v58, v58, v30
    v_add_f32 v59, v59, v31
    ds_write_b128 v10, v[56:59] offset:26880
    s_waitcnt lgkmcnt(6)
    v_add_f32 v60, v60, v32
    v_add_f32 v61, v61, v33
    v_add_f32 v62, v62, v34
    v_add_f32 v63, v63, v35
    ds_write_b128 v10, v[60:63] offset:26944
    s_waitcnt lgkmcnt(6)
    v_add_f32 v64, v64, v36
    v_add_f32 v65, v65, v37
    v_add_f32 v66, v66, v38
    v_add_f32 v67, v67, v39
    ds_write_b128 v10, v[64:67] offset:27008
    s_waitcnt lgkmcnt(0)
    ds_read_b128 v[12:15], v10 offset:27072
    ds_read_b128 v[16:19], v10 offset:27136
    ds_read_b128 v[20:23], v10 offset:32256
    ds_read_b128 v[24:27], v10 offset:32320
    ds_read_b128 v[28:31], v10 offset:32384
    ds_read_b128 v[32:35], v10 offset:32448
    ds_read_b128 v[36:39], v10 offset:32512
    v_accvgpr_read_b32 v40, a112
    v_accvgpr_read_b32 v41, a113
    v_accvgpr_read_b32 v42, a114
    v_accvgpr_read_b32 v43, a115
    v_accvgpr_read_b32 v44, a116
    v_accvgpr_read_b32 v45, a117
    v_accvgpr_read_b32 v46, a118
    v_accvgpr_read_b32 v47, a119
    v_accvgpr_read_b32 v48, a120
    v_accvgpr_read_b32 v49, a121
    v_accvgpr_read_b32 v50, a122
    v_accvgpr_read_b32 v51, a123
    v_accvgpr_read_b32 v52, a124
    v_accvgpr_read_b32 v53, a125
    v_accvgpr_read_b32 v54, a126
    v_accvgpr_read_b32 v55, a127
    v_accvgpr_read_b32 v56, a128
    v_accvgpr_read_b32 v57, a129
    v_accvgpr_read_b32 v58, a130
    v_accvgpr_read_b32 v59, a131
    v_accvgpr_read_b32 v60, a132
    v_accvgpr_read_b32 v61, a133
    v_accvgpr_read_b32 v62, a134
    v_accvgpr_read_b32 v63, a135
    v_accvgpr_read_b32 v64, a136
    v_accvgpr_read_b32 v65, a137
    v_accvgpr_read_b32 v66, a138
    v_accvgpr_read_b32 v67, a139
    s_waitcnt lgkmcnt(6)
    v_add_f32 v40, v40, v12
    v_add_f32 v41, v41, v13
    v_add_f32 v42, v42, v14
    v_add_f32 v43, v43, v15
    ds_write_b128 v10, v[40:43] offset:27072
    s_waitcnt lgkmcnt(6)
    v_add_f32 v44, v44, v16
    v_add_f32 v45, v45, v17
    v_add_f32 v46, v46, v18
    v_add_f32 v47, v47, v19
    ds_write_b128 v10, v[44:47] offset:27136
    s_waitcnt lgkmcnt(6)
    v_add_f32 v48, v48, v20
    v_add_f32 v49, v49, v21
    v_add_f32 v50, v50, v22
    v_add_f32 v51, v51, v23
    ds_write_b128 v10, v[48:51] offset:32256
    s_waitcnt lgkmcnt(6)
    v_add_f32 v52, v52, v24
    v_add_f32 v53, v53, v25
    v_add_f32 v54, v54, v26
    v_add_f32 v55, v55, v27
    ds_write_b128 v10, v[52:55] offset:32320
    s_waitcnt lgkmcnt(6)
    v_add_f32 v56, v56, v28
    v_add_f32 v57, v57, v29
    v_add_f32 v58, v58, v30
    v_add_f32 v59, v59, v31
    ds_write_b128 v10, v[56:59] offset:32384
    s_waitcnt lgkmcnt(6)
    v_add_f32 v60, v60, v32
    v_add_f32 v61, v61, v33
    v_add_f32 v62, v62, v34
    v_add_f32 v63, v63, v35
    ds_write_b128 v10, v[60:63] offset:32448
    s_waitcnt lgkmcnt(6)
    v_add_f32 v64, v64, v36
    v_add_f32 v65, v65, v37
    v_add_f32 v66, v66, v38
    v_add_f32 v67, v67, v39
    ds_write_b128 v10, v[64:67] offset:32512
    s_waitcnt lgkmcnt(0)
L_k2_hi2:
    s_nop 9
    s_barrier
    v_add_u32 v10, 0, v9
    v_mul_u32_u24 v11, 6554, v10
    v_lshrrev_b32 v11, 16, v11
    v_mul_u32_u24 v1, 10, v11
    v_sub_u32 v1, v10, v1
    v_mul_u32_u24 v2, 336, v11
    v_lshl_add_u32 v2, v1, 5, v2
    v_mul_u32_u24 v3, 2560, v11
    v_lshl_add_u32 v3, v1, 4, v3
    v_add_u32 v4, 75264, v2
    ds_read_b128 v[16:19], v2 offset:0
    ds_read_b128 v[20:23], v2 offset:16
    ds_read_b128 v[24:27], v2 offset:37632
    ds_read_b128 v[28:31], v2 offset:37648
    ds_read_b128 v[32:35], v4 offset:0
    ds_read_b128 v[36:39], v4 offset:16
    ds_read_b128 v[40:43], v4 offset:37632
    ds_read_b128 v[44:47], v4 offset:37648
    s_waitcnt lgkmcnt(0)
    v_add_f32 v16, v16, v24
    v_add_f32 v32, v32, v40
    v_add_f32 v17, v17, v25
    v_add_f32 v33, v33, v41
    v_add_f32 v18, v18, v26
    v_add_f32 v34, v34, v42
    v_add_f32 v19, v19, v27
    v_add_f32 v35, v35, v43
    v_add_f32 v20, v20, v28
    v_add_f32 v36, v36, v44
    v_add_f32 v21, v21, v29
    v_add_f32 v37, v37, v45
    v_add_f32 v22, v22, v30
    v_add_f32 v38, v38, v46
    v_add_f32 v23, v23, v31
    v_add_f32 v39, v39, v47
    v_add_f32 v16, v16, v32
    v_add_f32 v17, v17, v33
    v_add_f32 v18, v18, v34
    v_add_f32 v19, v19, v35
    v_add_f32 v20, v20, v36
    v_add_f32 v21, v21, v37
    v_add_f32 v22, v22, v38
    v_add_f32 v23, v23, v39
    v_cvt_pk_bf16_f32 v48, v16, v17
    v_cvt_pk_bf16_f32 v49, v18, v19
    v_cvt_pk_bf16_f32 v50, v20, v21
    v_cvt_pk_bf16_f32 v51, v22, v23
    buffer_store_dwordx4 v[48:51], v3, s[16:19], s31 offen
    v_add_u32 v10, 512, v9
    v_mul_u32_u24 v11, 6554, v10
    v_lshrrev_b32 v11, 16, v11
    v_mul_u32_u24 v1, 10, v11
    v_sub_u32 v1, v10, v1
    v_mul_u32_u24 v2, 336, v11
    v_lshl_add_u32 v2, v1, 5, v2
    v_mul_u32_u24 v3, 2560, v11
    v_lshl_add_u32 v3, v1, 4, v3
    v_add_u32 v4, 75264, v2
    ds_read_b128 v[16:19], v2 offset:0
    ds_read_b128 v[20:23], v2 offset:16
    ds_read_b128 v[24:27], v2 offset:37632
    ds_read_b128 v[28:31], v2 offset:37648
    ds_read_b128 v[32:35], v4 offset:0
    ds_read_b128 v[36:39], v4 offset:16
    ds_read_b128 v[40:43], v4 offset:37632
    ds_read_b128 v[44:47], v4 offset:37648
    s_waitcnt lgkmcnt(0)
    v_add_f32 v16, v16, v24
    v_add_f32 v32, v32, v40
    v_add_f32 v17, v17, v25
    v_add_f32 v33, v33, v41
    v_add_f32 v18, v18, v26
    v_add_f32 v34, v34, v42
    v_add_f32 v19, v19, v27
    v_add_f32 v35, v35, v43
    v_add_f32 v20, v20, v28
    v_add_f32 v36, v36, v44
    v_add_f32 v21, v21, v29
    v_add_f32 v37, v37, v45
    v_add_f32 v22, v22, v30
    v_add_f32 v38, v38, v46
    v_add_f32 v23, v23, v31
    v_add_f32 v39, v39, v47
    v_add_f32 v16, v16, v32
    v_add_f32 v17, v17, v33
    v_add_f32 v18, v18, v34
    v_add_f32 v19, v19, v35
    v_add_f32 v20, v20, v36
    v_add_f32 v21, v21, v37
    v_add_f32 v22, v22, v38
    v_add_f32 v23, v23, v39
    v_cvt_pk_bf16_f32 v52, v16, v17
    v_cvt_pk_bf16_f32 v53, v18, v19
    v_cvt_pk_bf16_f32 v54, v20, v21
    v_cvt_pk_bf16_f32 v55, v22, v23
    buffer_store_dwordx4 v[52:55], v3, s[16:19], s31 offen
    v_add_u32 v10, 1024, v9
    v_mul_u32_u24 v11, 6554, v10
    v_lshrrev_b32 v11, 16, v11
    v_mul_u32_u24 v1, 10, v11
    v_sub_u32 v1, v10, v1
    v_mul_u32_u24 v2, 336, v11
    v_lshl_add_u32 v2, v1, 5, v2
    v_mul_u32_u24 v3, 2560, v11
    v_lshl_add_u32 v3, v1, 4, v3
    v_cmp_gt_u32 vcc, 1120, v10
    s_nop 0
    s_and_saveexec_b64 s[44:45], vcc
    s_cbranch_execz L_k2_end
    v_add_u32 v4, 75264, v2
    ds_read_b128 v[16:19], v2 offset:0
    ds_read_b128 v[20:23], v2 offset:16
    ds_read_b128 v[24:27], v2 offset:37632
    ds_read_b128 v[28:31], v2 offset:37648
    ds_read_b128 v[32:35], v4 offset:0
    ds_read_b128 v[36:39], v4 offset:16
    ds_read_b128 v[40:43], v4 offset:37632
    ds_read_b128 v[44:47], v4 offset:37648
    s_waitcnt lgkmcnt(0)
    v_add_f32 v16, v16, v24
    v_add_f32 v32, v32, v40
    v_add_f32 v17, v17, v25
    v_add_f32 v33, v33, v41
    v_add_f32 v18, v18, v26
    v_add_f32 v34, v34, v42
    v_add_f32 v19, v19, v27
    v_add_f32 v35, v35, v43
    v_add_f32 v20, v20, v28
    v_add_f32 v36, v36, v44
    v_add_f32 v21, v21, v29
    v_add_f32 v37, v37, v45
    v_add_f32 v22, v22, v30
    v_add_f32 v38, v38, v46
    v_add_f32 v23, v23, v31
    v_add_f32 v39, v39, v47
    v_add_f32 v16, v16, v32
    v_add_f32 v17, v17, v33
    v_add_f32 v18, v18, v34
    v_add_f32 v19, v19, v35
    v_add_f32 v20, v20, v36
    v_add_f32 v21, v21, v37
    v_add_f32 v22, v22, v38
    v_add_f32 v23, v23, v39
    v_cvt_pk_bf16_f32 v48, v16, v17
    v_cvt_pk_bf16_f32 v49, v18, v19
    v_cvt_pk_bf16_f32 v50, v20, v21
    v_cvt_pk_bf16_f32 v51, v22, v23
    buffer_store_dwordx4 v[48:51], v3, s[16:19], s31 offen
L_k2_end:
    s_endpgm
.section .rodata,"a"
.p2align 6
.amdhsa_kernel attn_kernel
  .amdhsa_next_free_vgpr 256
  .amdhsa_next_free_sgpr 102
  .amdhsa_accum_offset 80
  .amdhsa_group_segment_fixed_size 0
  .amdhsa_kernarg_size 104
  .amdhsa_user_sgpr_count 2
  .amdhsa_user_sgpr_kernarg_segment_ptr 1
  .amdhsa_system_sgpr_workgroup_id_x 1
.end_amdhsa_kernel
.p2align 6
.amdhsa_kernel oproj_kernel
  .amdhsa_next_free_vgpr 252
  .amdhsa_next_free_sgpr 102
  .amdhsa_accum_offset 112
  .amdhsa_group_segment_fixed_size 0
  .amdhsa_kernarg_size 104
  .amdhsa_user_sgpr_count 2
  .amdhsa_user_sgpr_kernarg_segment_ptr 1
  .amdhsa_system_sgpr_workgroup_id_x 1
.end_amdhsa_kernel
```
